```python
import torch

def _softmax(x, axis=-1):
    return torch.softmax(x, dim=axis)
def _gelu(x):
    return torch.nn.functional.gelu(x, approximate="tanh")
def _silu(x):
    return torch.nn.functional.silu(x)
def _sigmoid(x):
    return torch.sigmoid(x)
def _layernorm(x, axis=-1, eps=1e-5):
    m = x.mean(dim=axis, keepdim=True)
    v = x.var(dim=axis, keepdim=True, unbiased=False)
    return (x - m) / torch.sqrt(v + eps)
def _scatter_add(tgt, idx, src, axis=0):
    return tgt.clone().index_add_(axis, idx, src)
def _segment_sum(src, seg, n):
    out = torch.zeros((n,) + src.shape[1:], dtype=src.dtype)
    return out.index_add_(0, seg, src)
def _pad(x, pw):
    flat = tuple(v for pair in reversed(pw) for v in pair)
    return torch.nn.functional.pad(x, flat)

kernel_name = 'parallel_sum__ssm_conv_h3__glu_gated_glu__prompt'

def setup_inputs():

    _w = (lambda a: (lambda t: t.to(torch.bfloat16) if t.is_floating_point() else t)(torch.as_tensor(a)))
    def _A_setup():
        B, S, D = 1, 2048, 640
        ks = 4
        return {
            "q": _w((lambda *s: torch.randn(*s, dtype=torch.bfloat16) * 0.05)(B, S, D)),
            "k": _w((lambda *s: torch.randn(*s, dtype=torch.bfloat16) * 0.4)(B, S, D)),
            "v": _w((lambda *s: torch.randn(*s, dtype=torch.bfloat16) * 0.4)(B, S, D)),
            "shift_k": _w((lambda *s: torch.randn(*s, dtype=torch.bfloat16) * 0.4)(D, ks) * 0.5),
            "ssm_k": _w((lambda *s: torch.randn(*s, dtype=torch.bfloat16) * 1.6)(D, S) * (1.0 / S ** 0.5)),
            "ssm_D": _w((lambda *s: torch.randn(*s, dtype=torch.bfloat16) * 0.4)(D)),
        }
    _A_in = _A_setup()

    def _B_setup():
        B, S, D, F = 1, 2048, 640, 1728
        return {
            "x": _w((lambda *s: torch.randn(*s, dtype=torch.bfloat16) * 0.05)(B, S, D)),
            "w_gate": _w((lambda *s: torch.randn(*s, dtype=torch.bfloat16) * 0.05)(D, F)),
            "w_up": _w((lambda *s: torch.randn(*s, dtype=torch.bfloat16) * 0.05)(D, F)),
            "w_down": _w((lambda *s: torch.randn(*s, dtype=torch.bfloat16) * 0.05)(F, D)),
        }
    _B_in = _B_setup()

    return {
        "A_q": _A_in["q"],
        "A_k": _A_in["k"],
        "A_v": _A_in["v"],
        "A_shift_k": _A_in["shift_k"],
        "A_ssm_k": _A_in["ssm_k"],
        "A_ssm_D": _A_in["ssm_D"],
        "B_x": _B_in["x"],
        "B_w_gate": _B_in["w_gate"],
        "B_w_up": _B_in["w_up"],
        "B_w_down": _B_in["w_down"],
    }

def reference(A_q, A_k, A_v, A_shift_k, A_ssm_k, A_ssm_D, B_x, B_w_gate, B_w_up, B_w_down):
    def _A_ref(q, k, v, shift_k, ssm_k, ssm_D):
        B, S, D = q.shape
        ks = shift_k.shape[-1]
        k_pad = _pad(k, ((0, 0), (ks - 1, 0), (0, 0)))
        k_shift = torch.zeros_like(k)
        for t in range(ks):
            k_shift = k_shift + k_pad[:, t:t + S, :] * shift_k[:, ks - 1 - t][None, None, :]
        kv = k_shift * v
        L = 2 * S
        kv_pad = _pad(kv, ((0, 0), (0, S), (0, 0)))
        kf_pad = _pad(ssm_k, ((0, 0), (0, S)))
        kv_f = (lambda x, axes=(-2,-1): torch.fft.rfft2(x.float(), dim=axes))(kv_pad[:, None, :, :], axes=(1, 2))
        kf_f = (lambda x, axes=(-2,-1): torch.fft.rfft2(x.float(), dim=axes))(kf_pad[:, None, :], axes=(1, 2))
        kf_f = (lambda x, *d: x.permute(*d))(kf_f, 1, 2, 0)
        y_f = kv_f * kf_f[None, :, :, :]
        y = (lambda x, s, axes=(-2,-1): torch.fft.irfft2(x, s=s, dim=axes).to(torch.bfloat16))(y_f, (1, L), axes=(1, 2))[:, 0, :S, :]
        y = y + kv * ssm_D[None, None, :]
        return q * y

    def _B_ref(x, w_gate, w_up, w_down):
        g = torch.einsum("bsd,df->bsf", x, w_gate)
        u = torch.einsum("bsd,df->bsf", x, w_up)
        h = _sigmoid(g) * u
        return torch.einsum("bsf,fd->bsd", h, w_down)

    x = A_q
    xn = _layernorm(x, axis=-1)
    return x + _A_ref(xn, A_k, A_v, A_shift_k, A_ssm_k, A_ssm_D) + _B_ref(xn, B_w_gate, B_w_up, B_w_down)
```

```asm
; @launch kernel=p0_kernel grid=(256,1,1) block=(512,1,1) lds=16384
; @launch kernel=g1_kernel grid=(256,1,1) block=(512,1,1) lds=147456
; @launch kernel=g2_kernel grid=(256,1,1) block=(512,1,1) lds=122880
.amdgcn_target "amdgcn-amd-amdhsa--gfx950"
.text
.globl p0_kernel
.p2align 8
.type p0_kernel,@function
p0_kernel:
    s_cmp_ge_u32 s2, 256
    s_cbranch_scc1 p0_kernel_END
    s_load_dwordx4 s[52:55], s[0:1], 0
    s_load_dwordx4 s[56:59], s[0:1], 16
    s_load_dwordx4 s[60:63], s[0:1], 32
    s_load_dwordx4 s[64:67], s[0:1], 56
    s_load_dwordx4 s[68:71], s[0:1], 72
    s_load_dwordx4 s[72:75], s[0:1], 88
    v_lshrrev_b32 v1, 6, v0
    s_nop 0
    v_readfirstlane_b32 s4, v1
    v_and_b32 v0, 63, v0
    s_waitcnt lgkmcnt(0)
    s_mov_b32 s8, s52
    s_and_b32 s9, s53, 0xffff
    s_mov_b32 s10, 2621440
    s_mov_b32 s11, 0x00020000
    s_mov_b32 s12, s54
    s_and_b32 s13, s55, 0xffff
    s_mov_b32 s14, 2621440
    s_mov_b32 s15, 0x00020000
    s_mov_b32 s16, s56
    s_and_b32 s17, s57, 0xffff
    s_mov_b32 s18, 2621440
    s_mov_b32 s19, 0x00020000
    s_mov_b32 s20, s58
    s_and_b32 s21, s59, 0xffff
    s_mov_b32 s22, 5120
    s_mov_b32 s23, 0x00020000
    s_mov_b32 s24, s60
    s_and_b32 s25, s61, 0xffff
    s_mov_b32 s26, 2621440
    s_mov_b32 s27, 0x00020000
    s_mov_b32 s28, s62
    s_and_b32 s29, s63, 0xffff
    s_mov_b32 s30, 1280
    s_mov_b32 s31, 0x00020000
    s_mov_b32 s32, s64
    s_and_b32 s33, s65, 0xffff
    s_mov_b32 s34, 2211840
    s_mov_b32 s35, 0x00020000
    s_mov_b32 s36, s66
    s_and_b32 s37, s67, 0xffff
    s_mov_b32 s38, 2211840
    s_mov_b32 s39, 0x00020000
    s_mov_b32 s40, s68
    s_and_b32 s41, s69, 0xffff
    s_mov_b32 s42, 2211840
    s_mov_b32 s43, 0x00020000
    s_mov_b32 s44, s70
    s_and_b32 s45, s71, 0xffff
    s_mov_b32 s46, 2621440
    s_mov_b32 s47, 0x00020000
    s_mov_b32 s48, s74
    s_and_b32 s49, s75, 0xffff
    s_mov_b32 s50, 33554432
    s_mov_b32 s51, 0x00020000
    s_lshl_b32 s5, s2, 3
    s_add_u32 s5, s5, s4
    s_mul_i32 s6, s5, 1280
    v_mul_u32_u24 v1, 20, v0
    v_mov_b32 v2, s6
    v_add_u32 v2, v2, v1
    buffer_load_dwordx4 v[10:13], v2, s[8:11], 0 offen
    buffer_load_dword v14, v2, s[8:11], 0 offen offset:16
    buffer_load_dwordx4 v[16:19], v2, s[16:19], 0 offen
    buffer_load_dword v20, v2, s[16:19], 0 offen offset:16
    buffer_load_dwordx4 v[24:27], v2, s[12:15], 0 offen
    buffer_load_dword v28, v2, s[12:15], 0 offen offset:16
    v_subrev_u32 v3, 1280, v2
    buffer_load_dwordx4 v[30:33], v3, s[12:15], 0 offen
    buffer_load_dword v34, v3, s[12:15], 0 offen offset:16
    v_subrev_u32 v3, 2560, v2
    buffer_load_dwordx4 v[36:39], v3, s[12:15], 0 offen
    buffer_load_dword v40, v3, s[12:15], 0 offen offset:16
    v_subrev_u32 v3, 3840, v2
    buffer_load_dwordx4 v[42:45], v3, s[12:15], 0 offen
    buffer_load_dword v46, v3, s[12:15], 0 offen offset:16
    v_mul_u32_u24 v4, 80, v0
    buffer_load_dwordx4 v[48:51], v4, s[20:23], 0 offen offset:0
    buffer_load_dwordx4 v[52:55], v4, s[20:23], 0 offen offset:16
    buffer_load_dwordx4 v[56:59], v4, s[20:23], 0 offen offset:32
    buffer_load_dwordx4 v[60:63], v4, s[20:23], 0 offen offset:48
    buffer_load_dwordx4 v[64:67], v4, s[20:23], 0 offen offset:64
    s_waitcnt vmcnt(14)
    v_lshlrev_b32 v70, 16, v10
    v_and_b32 v71, 0xffff0000, v10
    v_lshlrev_b32 v72, 16, v11
    v_and_b32 v73, 0xffff0000, v11
    v_lshlrev_b32 v74, 16, v12
    v_and_b32 v75, 0xffff0000, v12
    v_lshlrev_b32 v76, 16, v13
    v_and_b32 v77, 0xffff0000, v13
    v_lshlrev_b32 v78, 16, v14
    v_and_b32 v79, 0xffff0000, v14
    v_mov_b32 v5, 0
    v_mov_b32 v6, 0
    v_add_f32 v5, v5, v70
    v_fmac_f32 v6, v70, v70
    v_add_f32 v5, v5, v71
    v_fmac_f32 v6, v71, v71
    v_add_f32 v5, v5, v72
    v_fmac_f32 v6, v72, v72
    v_add_f32 v5, v5, v73
    v_fmac_f32 v6, v73, v73
    v_add_f32 v5, v5, v74
    v_fmac_f32 v6, v74, v74
    v_add_f32 v5, v5, v75
    v_fmac_f32 v6, v75, v75
    v_add_f32 v5, v5, v76
    v_fmac_f32 v6, v76, v76
    v_add_f32 v5, v5, v77
    v_fmac_f32 v6, v77, v77
    v_add_f32 v5, v5, v78
    v_fmac_f32 v6, v78, v78
    v_add_f32 v5, v5, v79
    v_fmac_f32 v6, v79, v79
    s_nop 1
    v_add_f32_dpp v5, v5, v5 row_shr:1 row_mask:0xf bank_mask:0xf bound_ctrl:0
    s_nop 1
    v_add_f32_dpp v5, v5, v5 row_shr:2 row_mask:0xf bank_mask:0xf bound_ctrl:0
    s_nop 1
    v_add_f32_dpp v5, v5, v5 row_shr:4 row_mask:0xf bank_mask:0xf bound_ctrl:0
    s_nop 1
    v_add_f32_dpp v5, v5, v5 row_shr:8 row_mask:0xf bank_mask:0xf bound_ctrl:0
    s_nop 1
    v_add_f32_dpp v5, v5, v5 row_bcast:15 row_mask:0xa bank_mask:0xf
    s_nop 1
    v_add_f32_dpp v5, v5, v5 row_bcast:31 row_mask:0xc bank_mask:0xf
    s_nop 1
    s_nop 1
    v_add_f32_dpp v6, v6, v6 row_shr:1 row_mask:0xf bank_mask:0xf bound_ctrl:0
    s_nop 1
    v_add_f32_dpp v6, v6, v6 row_shr:2 row_mask:0xf bank_mask:0xf bound_ctrl:0
    s_nop 1
    v_add_f32_dpp v6, v6, v6 row_shr:4 row_mask:0xf bank_mask:0xf bound_ctrl:0
    s_nop 1
    v_add_f32_dpp v6, v6, v6 row_shr:8 row_mask:0xf bank_mask:0xf bound_ctrl:0
    s_nop 1
    v_add_f32_dpp v6, v6, v6 row_bcast:15 row_mask:0xa bank_mask:0xf
    s_nop 1
    v_add_f32_dpp v6, v6, v6 row_bcast:31 row_mask:0xc bank_mask:0xf
    s_nop 1
    v_readlane_b32 s6, v5, 63
    v_readlane_b32 s7, v6, 63
    s_nop 1
    v_mov_b32 v5, s6
    v_mov_b32 v6, s7
    v_mul_f32 v5, 0x3acccccd, v5
    v_mul_f32 v6, 0x3acccccd, v6
    v_fma_f32 v6, -v5, v5, v6
    v_cvt_pk_bf16_f32 v7, v5, v6
    v_lshlrev_b32 v5, 16, v7
    v_and_b32 v6, 0xffff0000, v7
    v_add_f32 v6, 0x3727c5ac, v6
    v_mov_b32 v8, 0
    v_cvt_pk_bf16_f32 v7, v6, v8
    v_lshlrev_b32 v6, 16, v7
    v_and_b32 v8, 0xffff0000, v7
    v_sqrt_f32 v6, v6
    s_nop 0
    v_cvt_pk_bf16_f32 v7, v6, v8
    v_lshlrev_b32 v6, 16, v7
    v_and_b32 v8, 0xffff0000, v7
    v_rcp_f32 v9, v6
    v_sub_f32 v70, v70, v5
    v_sub_f32 v71, v71, v5
    v_sub_f32 v72, v72, v5
    v_sub_f32 v73, v73, v5
    v_sub_f32 v74, v74, v5
    v_sub_f32 v75, v75, v5
    v_sub_f32 v76, v76, v5
    v_sub_f32 v77, v77, v5
    v_sub_f32 v78, v78, v5
    v_sub_f32 v79, v79, v5
    v_cvt_pk_bf16_f32 v7, v70, v71
    v_lshlrev_b32 v70, 16, v7
    v_and_b32 v71, 0xffff0000, v7
    v_cvt_pk_bf16_f32 v7, v72, v73
    v_lshlrev_b32 v72, 16, v7
    v_and_b32 v73, 0xffff0000, v7
    v_cvt_pk_bf16_f32 v7, v74, v75
    v_lshlrev_b32 v74, 16, v7
    v_and_b32 v75, 0xffff0000, v7
    v_cvt_pk_bf16_f32 v7, v76, v77
    v_lshlrev_b32 v76, 16, v7
    v_and_b32 v77, 0xffff0000, v7
    v_cvt_pk_bf16_f32 v7, v78, v79
    v_lshlrev_b32 v78, 16, v7
    v_and_b32 v79, 0xffff0000, v7
    v_mul_f32 v80, v70, v9
    v_fma_f32 v70, -v80, v6, v70
    v_fmac_f32 v80, v70, v9
    v_mul_f32 v81, v71, v9
    v_fma_f32 v71, -v81, v6, v71
    v_fmac_f32 v81, v71, v9
    v_mul_f32 v82, v72, v9
    v_fma_f32 v72, -v82, v6, v72
    v_fmac_f32 v82, v72, v9
    v_mul_f32 v83, v73, v9
    v_fma_f32 v73, -v83, v6, v73
    v_fmac_f32 v83, v73, v9
    v_mul_f32 v84, v74, v9
    v_fma_f32 v74, -v84, v6, v74
    v_fmac_f32 v84, v74, v9
    v_mul_f32 v85, v75, v9
    v_fma_f32 v75, -v85, v6, v75
    v_fmac_f32 v85, v75, v9
    v_mul_f32 v86, v76, v9
    v_fma_f32 v76, -v86, v6, v76
    v_fmac_f32 v86, v76, v9
    v_mul_f32 v87, v77, v9
    v_fma_f32 v77, -v87, v6, v77
    v_fmac_f32 v87, v77, v9
    v_mul_f32 v88, v78, v9
    v_fma_f32 v78, -v88, v6, v78
    v_fmac_f32 v88, v78, v9
    v_mul_f32 v89, v79, v9
    v_fma_f32 v79, -v89, v6, v79
    v_fmac_f32 v89, v79, v9
    v_cvt_pk_bf16_f32 v10, v80, v81
    v_cvt_pk_bf16_f32 v11, v82, v83
    v_cvt_pk_bf16_f32 v12, v84, v85
    v_cvt_pk_bf16_f32 v13, v86, v87
    v_cvt_pk_bf16_f32 v14, v88, v89
    v_add_u32 v3, 0, v2
    buffer_store_dwordx4 v[10:13], v3, s[48:51], 0 offen
    buffer_store_dword v14, v3, s[48:51], 0 offen offset:16
    s_waitcnt vmcnt(2)
    v_lshlrev_b32 v70, 16, v16
    v_and_b32 v71, 0xffff0000, v16
    v_lshlrev_b32 v72, 16, v17
    v_and_b32 v73, 0xffff0000, v17
    v_lshlrev_b32 v74, 16, v18
    v_and_b32 v75, 0xffff0000, v18
    v_lshlrev_b32 v76, 16, v19
    v_and_b32 v77, 0xffff0000, v19
    v_lshlrev_b32 v78, 16, v20
    v_and_b32 v79, 0xffff0000, v20
    v_lshlrev_b32 v90, 16, v24
    v_and_b32 v91, 0xffff0000, v24
    v_lshlrev_b32 v92, 16, v25
    v_and_b32 v93, 0xffff0000, v25
    v_lshlrev_b32 v94, 16, v26
    v_and_b32 v95, 0xffff0000, v26
    v_lshlrev_b32 v96, 16, v27
    v_and_b32 v97, 0xffff0000, v27
    v_lshlrev_b32 v98, 16, v28
    v_and_b32 v99, 0xffff0000, v28
    v_lshlrev_b32 v100, 16, v30
    v_and_b32 v101, 0xffff0000, v30
    v_lshlrev_b32 v102, 16, v31
    v_and_b32 v103, 0xffff0000, v31
    v_lshlrev_b32 v104, 16, v32
    v_and_b32 v105, 0xffff0000, v32
    v_lshlrev_b32 v106, 16, v33
    v_and_b32 v107, 0xffff0000, v33
    v_lshlrev_b32 v108, 16, v34
    v_and_b32 v109, 0xffff0000, v34
    v_lshlrev_b32 v110, 16, v36
    v_and_b32 v111, 0xffff0000, v36
    v_lshlrev_b32 v112, 16, v37
    v_and_b32 v113, 0xffff0000, v37
    v_lshlrev_b32 v114, 16, v38
    v_and_b32 v115, 0xffff0000, v38
    v_lshlrev_b32 v116, 16, v39
    v_and_b32 v117, 0xffff0000, v39
    v_lshlrev_b32 v118, 16, v40
    v_and_b32 v119, 0xffff0000, v40
    v_lshlrev_b32 v120, 16, v42
    v_and_b32 v121, 0xffff0000, v42
    v_lshlrev_b32 v122, 16, v43
    v_and_b32 v123, 0xffff0000, v43
    v_lshlrev_b32 v124, 16, v44
    v_and_b32 v125, 0xffff0000, v44
    v_lshlrev_b32 v126, 16, v45
    v_and_b32 v127, 0xffff0000, v45
    v_lshlrev_b32 v128, 16, v46
    v_and_b32 v129, 0xffff0000, v46
    v_lshlrev_b32 v4, 16, v48
    v_and_b32 v5, 0xffff0000, v48
    v_lshlrev_b32 v6, 16, v49
    v_and_b32 v7, 0xffff0000, v49
    v_mul_f32 v4, v4, v90
    v_mul_f32 v5, v5, v100
    v_mul_f32 v6, v6, v110
    v_mul_f32 v7, v7, v120
    v_cvt_pk_bf16_f32 v8, v4, v5
    v_lshlrev_b32 v4, 16, v8
    v_and_b32 v5, 0xffff0000, v8
    v_cvt_pk_bf16_f32 v8, v6, v7
    v_lshlrev_b32 v6, 16, v8
    v_and_b32 v7, 0xffff0000, v8
    v_add_f32 v7, v7, v6
    v_cvt_pk_bf16_f32 v8, v7, v9
    v_lshlrev_b32 v7, 16, v8
    v_and_b32 v9, 0xffff0000, v8
    v_add_f32 v7, v7, v5
    v_cvt_pk_bf16_f32 v8, v7, v9
    v_lshlrev_b32 v7, 16, v8
    v_and_b32 v9, 0xffff0000, v8
    v_add_f32 v7, v7, v4
    v_cvt_pk_bf16_f32 v8, v7, v9
    v_lshlrev_b32 v7, 16, v8
    v_and_b32 v9, 0xffff0000, v8
    v_mul_f32 v130, v7, v70
    v_lshlrev_b32 v4, 16, v50
    v_and_b32 v5, 0xffff0000, v50
    v_lshlrev_b32 v6, 16, v51
    v_and_b32 v7, 0xffff0000, v51
    v_mul_f32 v4, v4, v91
    v_mul_f32 v5, v5, v101
    v_mul_f32 v6, v6, v111
    v_mul_f32 v7, v7, v121
    v_cvt_pk_bf16_f32 v8, v4, v5
    v_lshlrev_b32 v4, 16, v8
    v_and_b32 v5, 0xffff0000, v8
    v_cvt_pk_bf16_f32 v8, v6, v7
    v_lshlrev_b32 v6, 16, v8
    v_and_b32 v7, 0xffff0000, v8
    v_add_f32 v7, v7, v6
    v_cvt_pk_bf16_f32 v8, v7, v9
    v_lshlrev_b32 v7, 16, v8
    v_and_b32 v9, 0xffff0000, v8
    v_add_f32 v7, v7, v5
    v_cvt_pk_bf16_f32 v8, v7, v9
    v_lshlrev_b32 v7, 16, v8
    v_and_b32 v9, 0xffff0000, v8
    v_add_f32 v7, v7, v4
    v_cvt_pk_bf16_f32 v8, v7, v9
    v_lshlrev_b32 v7, 16, v8
    v_and_b32 v9, 0xffff0000, v8
    v_mul_f32 v131, v7, v71
    v_lshlrev_b32 v4, 16, v52
    v_and_b32 v5, 0xffff0000, v52
    v_lshlrev_b32 v6, 16, v53
    v_and_b32 v7, 0xffff0000, v53
    v_mul_f32 v4, v4, v92
    v_mul_f32 v5, v5, v102
    v_mul_f32 v6, v6, v112
    v_mul_f32 v7, v7, v122
    v_cvt_pk_bf16_f32 v8, v4, v5
    v_lshlrev_b32 v4, 16, v8
    v_and_b32 v5, 0xffff0000, v8
    v_cvt_pk_bf16_f32 v8, v6, v7
    v_lshlrev_b32 v6, 16, v8
    v_and_b32 v7, 0xffff0000, v8
    v_add_f32 v7, v7, v6
    v_cvt_pk_bf16_f32 v8, v7, v9
    v_lshlrev_b32 v7, 16, v8
    v_and_b32 v9, 0xffff0000, v8
    v_add_f32 v7, v7, v5
    v_cvt_pk_bf16_f32 v8, v7, v9
    v_lshlrev_b32 v7, 16, v8
    v_and_b32 v9, 0xffff0000, v8
    v_add_f32 v7, v7, v4
    v_cvt_pk_bf16_f32 v8, v7, v9
    v_lshlrev_b32 v7, 16, v8
    v_and_b32 v9, 0xffff0000, v8
    v_mul_f32 v132, v7, v72
    v_lshlrev_b32 v4, 16, v54
    v_and_b32 v5, 0xffff0000, v54
    v_lshlrev_b32 v6, 16, v55
    v_and_b32 v7, 0xffff0000, v55
    v_mul_f32 v4, v4, v93
    v_mul_f32 v5, v5, v103
    v_mul_f32 v6, v6, v113
    v_mul_f32 v7, v7, v123
    v_cvt_pk_bf16_f32 v8, v4, v5
    v_lshlrev_b32 v4, 16, v8
    v_and_b32 v5, 0xffff0000, v8
    v_cvt_pk_bf16_f32 v8, v6, v7
    v_lshlrev_b32 v6, 16, v8
    v_and_b32 v7, 0xffff0000, v8
    v_add_f32 v7, v7, v6
    v_cvt_pk_bf16_f32 v8, v7, v9
    v_lshlrev_b32 v7, 16, v8
    v_and_b32 v9, 0xffff0000, v8
    v_add_f32 v7, v7, v5
    v_cvt_pk_bf16_f32 v8, v7, v9
    v_lshlrev_b32 v7, 16, v8
    v_and_b32 v9, 0xffff0000, v8
    v_add_f32 v7, v7, v4
    v_cvt_pk_bf16_f32 v8, v7, v9
    v_lshlrev_b32 v7, 16, v8
    v_and_b32 v9, 0xffff0000, v8
    v_mul_f32 v133, v7, v73
    v_lshlrev_b32 v4, 16, v56
    v_and_b32 v5, 0xffff0000, v56
    v_lshlrev_b32 v6, 16, v57
    v_and_b32 v7, 0xffff0000, v57
    v_mul_f32 v4, v4, v94
    v_mul_f32 v5, v5, v104
    v_mul_f32 v6, v6, v114
    v_mul_f32 v7, v7, v124
    v_cvt_pk_bf16_f32 v8, v4, v5
    v_lshlrev_b32 v4, 16, v8
    v_and_b32 v5, 0xffff0000, v8
    v_cvt_pk_bf16_f32 v8, v6, v7
    v_lshlrev_b32 v6, 16, v8
    v_and_b32 v7, 0xffff0000, v8
    v_add_f32 v7, v7, v6
    v_cvt_pk_bf16_f32 v8, v7, v9
    v_lshlrev_b32 v7, 16, v8
    v_and_b32 v9, 0xffff0000, v8
    v_add_f32 v7, v7, v5
    v_cvt_pk_bf16_f32 v8, v7, v9
    v_lshlrev_b32 v7, 16, v8
    v_and_b32 v9, 0xffff0000, v8
    v_add_f32 v7, v7, v4
    v_cvt_pk_bf16_f32 v8, v7, v9
    v_lshlrev_b32 v7, 16, v8
    v_and_b32 v9, 0xffff0000, v8
    v_mul_f32 v134, v7, v74
    v_lshlrev_b32 v4, 16, v58
    v_and_b32 v5, 0xffff0000, v58
    v_lshlrev_b32 v6, 16, v59
    v_and_b32 v7, 0xffff0000, v59
    v_mul_f32 v4, v4, v95
    v_mul_f32 v5, v5, v105
    v_mul_f32 v6, v6, v115
    v_mul_f32 v7, v7, v125
    v_cvt_pk_bf16_f32 v8, v4, v5
    v_lshlrev_b32 v4, 16, v8
    v_and_b32 v5, 0xffff0000, v8
    v_cvt_pk_bf16_f32 v8, v6, v7
    v_lshlrev_b32 v6, 16, v8
    v_and_b32 v7, 0xffff0000, v8
    v_add_f32 v7, v7, v6
    v_cvt_pk_bf16_f32 v8, v7, v9
    v_lshlrev_b32 v7, 16, v8
    v_and_b32 v9, 0xffff0000, v8
    v_add_f32 v7, v7, v5
    v_cvt_pk_bf16_f32 v8, v7, v9
    v_lshlrev_b32 v7, 16, v8
    v_and_b32 v9, 0xffff0000, v8
    v_add_f32 v7, v7, v4
    v_cvt_pk_bf16_f32 v8, v7, v9
    v_lshlrev_b32 v7, 16, v8
    v_and_b32 v9, 0xffff0000, v8
    v_mul_f32 v135, v7, v75
    v_lshlrev_b32 v4, 16, v60
    v_and_b32 v5, 0xffff0000, v60
    v_lshlrev_b32 v6, 16, v61
    v_and_b32 v7, 0xffff0000, v61
    v_mul_f32 v4, v4, v96
    v_mul_f32 v5, v5, v106
    v_mul_f32 v6, v6, v116
    v_mul_f32 v7, v7, v126
    v_cvt_pk_bf16_f32 v8, v4, v5
    v_lshlrev_b32 v4, 16, v8
    v_and_b32 v5, 0xffff0000, v8
    v_cvt_pk_bf16_f32 v8, v6, v7
    v_lshlrev_b32 v6, 16, v8
    v_and_b32 v7, 0xffff0000, v8
    v_add_f32 v7, v7, v6
    v_cvt_pk_bf16_f32 v8, v7, v9
    v_lshlrev_b32 v7, 16, v8
    v_and_b32 v9, 0xffff0000, v8
    v_add_f32 v7, v7, v5
    v_cvt_pk_bf16_f32 v8, v7, v9
    v_lshlrev_b32 v7, 16, v8
    v_and_b32 v9, 0xffff0000, v8
    v_add_f32 v7, v7, v4
    v_cvt_pk_bf16_f32 v8, v7, v9
    v_lshlrev_b32 v7, 16, v8
    v_and_b32 v9, 0xffff0000, v8
    v_mul_f32 v136, v7, v76
    v_lshlrev_b32 v4, 16, v62
    v_and_b32 v5, 0xffff0000, v62
    v_lshlrev_b32 v6, 16, v63
    v_and_b32 v7, 0xffff0000, v63
    v_mul_f32 v4, v4, v97
    v_mul_f32 v5, v5, v107
    v_mul_f32 v6, v6, v117
    v_mul_f32 v7, v7, v127
    v_cvt_pk_bf16_f32 v8, v4, v5
    v_lshlrev_b32 v4, 16, v8
    v_and_b32 v5, 0xffff0000, v8
    v_cvt_pk_bf16_f32 v8, v6, v7
    v_lshlrev_b32 v6, 16, v8
    v_and_b32 v7, 0xffff0000, v8
    v_add_f32 v7, v7, v6
    v_cvt_pk_bf16_f32 v8, v7, v9
    v_lshlrev_b32 v7, 16, v8
    v_and_b32 v9, 0xffff0000, v8
    v_add_f32 v7, v7, v5
    v_cvt_pk_bf16_f32 v8, v7, v9
    v_lshlrev_b32 v7, 16, v8
    v_and_b32 v9, 0xffff0000, v8
    v_add_f32 v7, v7, v4
    v_cvt_pk_bf16_f32 v8, v7, v9
    v_lshlrev_b32 v7, 16, v8
    v_and_b32 v9, 0xffff0000, v8
    v_mul_f32 v137, v7, v77
    v_lshlrev_b32 v4, 16, v64
    v_and_b32 v5, 0xffff0000, v64
    v_lshlrev_b32 v6, 16, v65
    v_and_b32 v7, 0xffff0000, v65
    v_mul_f32 v4, v4, v98
    v_mul_f32 v5, v5, v108
    v_mul_f32 v6, v6, v118
    v_mul_f32 v7, v7, v128
    v_cvt_pk_bf16_f32 v8, v4, v5
    v_lshlrev_b32 v4, 16, v8
    v_and_b32 v5, 0xffff0000, v8
    v_cvt_pk_bf16_f32 v8, v6, v7
    v_lshlrev_b32 v6, 16, v8
    v_and_b32 v7, 0xffff0000, v8
    v_add_f32 v7, v7, v6
    v_cvt_pk_bf16_f32 v8, v7, v9
    v_lshlrev_b32 v7, 16, v8
    v_and_b32 v9, 0xffff0000, v8
    v_add_f32 v7, v7, v5
    v_cvt_pk_bf16_f32 v8, v7, v9
    v_lshlrev_b32 v7, 16, v8
    v_and_b32 v9, 0xffff0000, v8
    v_add_f32 v7, v7, v4
    v_cvt_pk_bf16_f32 v8, v7, v9
    v_lshlrev_b32 v7, 16, v8
    v_and_b32 v9, 0xffff0000, v8
    v_mul_f32 v138, v7, v78
    v_lshlrev_b32 v4, 16, v66
    v_and_b32 v5, 0xffff0000, v66
    v_lshlrev_b32 v6, 16, v67
    v_and_b32 v7, 0xffff0000, v67
    v_mul_f32 v4, v4, v99
    v_mul_f32 v5, v5, v109
    v_mul_f32 v6, v6, v119
    v_mul_f32 v7, v7, v129
    v_cvt_pk_bf16_f32 v8, v4, v5
    v_lshlrev_b32 v4, 16, v8
    v_and_b32 v5, 0xffff0000, v8
    v_cvt_pk_bf16_f32 v8, v6, v7
    v_lshlrev_b32 v6, 16, v8
    v_and_b32 v7, 0xffff0000, v8
    v_add_f32 v7, v7, v6
    v_cvt_pk_bf16_f32 v8, v7, v9
    v_lshlrev_b32 v7, 16, v8
    v_and_b32 v9, 0xffff0000, v8
    v_add_f32 v7, v7, v5
    v_cvt_pk_bf16_f32 v8, v7, v9
    v_lshlrev_b32 v7, 16, v8
    v_and_b32 v9, 0xffff0000, v8
    v_add_f32 v7, v7, v4
    v_cvt_pk_bf16_f32 v8, v7, v9
    v_lshlrev_b32 v7, 16, v8
    v_and_b32 v9, 0xffff0000, v8
    v_mul_f32 v139, v7, v79
    s_lshl_b32 s6, s4, 1
    v_mul_u32_u24 v4, 160, v0
    v_add_u32 v4, s6, v4
    v_cvt_pk_bf16_f32 v5, v130, v131
    ds_write_b16 v4, v5 offset:0
    ds_write_b16_d16_hi v4, v5 offset:16
    v_cvt_pk_bf16_f32 v5, v132, v133
    ds_write_b16 v4, v5 offset:32
    ds_write_b16_d16_hi v4, v5 offset:48
    v_cvt_pk_bf16_f32 v5, v134, v135
    ds_write_b16 v4, v5 offset:64
    ds_write_b16_d16_hi v4, v5 offset:80
    v_cvt_pk_bf16_f32 v5, v136, v137
    ds_write_b16 v4, v5 offset:96
    ds_write_b16_d16_hi v4, v5 offset:112
    v_cvt_pk_bf16_f32 v5, v138, v139
    ds_write_b16 v4, v5 offset:128
    ds_write_b16_d16_hi v4, v5 offset:144
    s_waitcnt lgkmcnt(0)
    s_barrier
    s_lshl_b32 s6, s4, 6
    v_add_u32 v4, s6, v0
    v_lshlrev_b32 v5, 4, v4
    ds_read_b128 v[8:11], v5
    ds_read_b128 v[12:15], v5 offset:8192
    v_lshlrev_b32 v5, 12, v4
    s_lshl_b32 s6, s2, 4
    s_add_u32 s6, s6, 3145728
    v_add_u32 v5, s6, v5
    s_waitcnt lgkmcnt(0)
    buffer_store_dwordx4 v[8:11], v5, s[48:51], 0 offen
    v_cmp_gt_u32 vcc, 128, v4
    s_and_saveexec_b64 s[6:7], vcc
    s_cbranch_execz P0_SKIP
    v_add_u32 v5, 2097152, v5
    buffer_store_dwordx4 v[12:15], v5, s[48:51], 0 offen
P0_SKIP:
    s_mov_b64 exec, s[6:7]
p0_kernel_END:
    s_endpgm
.globl g1_kernel
.p2align 8
.type g1_kernel,@function
g1_kernel:
    s_cmp_ge_u32 s2, 256
    s_cbranch_scc1 g1_kernel_END
    s_load_dwordx4 s[52:55], s[0:1], 0
    s_load_dwordx4 s[56:59], s[0:1], 16
    s_load_dwordx4 s[60:63], s[0:1], 32
    s_load_dwordx4 s[64:67], s[0:1], 56
    s_load_dwordx4 s[68:71], s[0:1], 72
    s_load_dwordx4 s[72:75], s[0:1], 88
    v_lshrrev_b32 v1, 6, v0
    s_nop 0
    v_readfirstlane_b32 s4, v1
    v_and_b32 v0, 63, v0
    s_waitcnt lgkmcnt(0)
    s_mov_b32 s8, s52
    s_and_b32 s9, s53, 0xffff
    s_mov_b32 s10, 2621440
    s_mov_b32 s11, 0x00020000
    s_mov_b32 s12, s54
    s_and_b32 s13, s55, 0xffff
    s_mov_b32 s14, 2621440
    s_mov_b32 s15, 0x00020000
    s_mov_b32 s16, s56
    s_and_b32 s17, s57, 0xffff
    s_mov_b32 s18, 2621440
    s_mov_b32 s19, 0x00020000
    s_mov_b32 s20, s58
    s_and_b32 s21, s59, 0xffff
    s_mov_b32 s22, 5120
    s_mov_b32 s23, 0x00020000
    s_mov_b32 s24, s60
    s_and_b32 s25, s61, 0xffff
    s_mov_b32 s26, 2621440
    s_mov_b32 s27, 0x00020000
    s_mov_b32 s28, s62
    s_and_b32 s29, s63, 0xffff
    s_mov_b32 s30, 1280
    s_mov_b32 s31, 0x00020000
    s_mov_b32 s32, s64
    s_and_b32 s33, s65, 0xffff
    s_mov_b32 s34, 2211840
    s_mov_b32 s35, 0x00020000
    s_mov_b32 s36, s66
    s_and_b32 s37, s67, 0xffff
    s_mov_b32 s38, 2211840
    s_mov_b32 s39, 0x00020000
    s_mov_b32 s40, s68
    s_and_b32 s41, s69, 0xffff
    s_mov_b32 s42, 2211840
    s_mov_b32 s43, 0x00020000
    s_mov_b32 s44, s70
    s_and_b32 s45, s71, 0xffff
    s_mov_b32 s46, 2621440
    s_mov_b32 s47, 0x00020000
    s_mov_b32 s48, s74
    s_and_b32 s49, s75, 0xffff
    s_mov_b32 s50, 33554432
    s_mov_b32 s51, 0x00020000
    s_cmp_ge_u32 s2, 216
    s_cbranch_scc1 NOG1
    s_mov_b32 s5, 159072863
    s_mul_hi_u32 s76, s2, s5
    s_mul_i32 s5, s76, 27
    s_sub_u32 s77, s2, s5
    v_lshrrev_b32 v7, 3, v0
    v_and_b32 v8, 7, v0
    s_lshl_b32 s5, s4, 5
    s_add_u32 s5, s5, 0
    v_add_u32 v9, s5, v7
    v_lshrrev_b32 v10, 1, v9
    v_and_b32 v10, 7, v10
    v_xor_b32 v10, v10, v8
    s_lshl_b32 s5, s76, 8
    v_add_u32 v9, s5, v9
    s_mov_b32 s5, 1280
    v_mul_lo_u32 v9, v9, s5
    v_lshl_add_u32 v2, v10, 4, v9
    s_lshl_b32 s5, s4, 5
    s_add_u32 s5, s5, 8
    v_add_u32 v9, s5, v7
    v_lshrrev_b32 v10, 1, v9
    v_and_b32 v10, 7, v10
    v_xor_b32 v10, v10, v8
    s_lshl_b32 s5, s76, 8
    v_add_u32 v9, s5, v9
    s_mov_b32 s5, 1280
    v_mul_lo_u32 v9, v9, s5
    v_lshl_add_u32 v3, v10, 4, v9
    s_lshl_b32 s5, s4, 5
    s_add_u32 s5, s5, 16
    v_add_u32 v9, s5, v7
    v_lshrrev_b32 v10, 1, v9
    v_and_b32 v10, 7, v10
    v_xor_b32 v10, v10, v8
    s_lshl_b32 s5, s76, 8
    v_add_u32 v9, s5, v9
    s_mov_b32 s5, 1280
    v_mul_lo_u32 v9, v9, s5
    v_lshl_add_u32 v4, v10, 4, v9
    s_lshl_b32 s5, s4, 5
    s_add_u32 s5, s5, 24
    v_add_u32 v9, s5, v7
    v_lshrrev_b32 v10, 1, v9
    v_and_b32 v10, 7, v10
    v_xor_b32 v10, v10, v8
    s_lshl_b32 s5, s76, 8
    v_add_u32 v9, s5, v9
    s_mov_b32 s5, 1280
    v_mul_lo_u32 v9, v9, s5
    v_lshl_add_u32 v5, v10, 4, v9
    s_lshl_b32 s5, s4, 3
    v_add_u32 v9, s5, v7
    v_lshrrev_b32 v10, 1, v9
    v_and_b32 v10, 1, v10
    v_lshrrev_b32 v11, 2, v8
    v_xor_b32 v10, v10, v11
    v_and_b32 v11, 3, v8
    v_lshl_add_u32 v10, v10, 2, v11
    s_mov_b32 s5, 3456
    v_mul_lo_u32 v9, v9, s5
    v_lshl_add_u32 v6, v10, 4, v9
    s_lshl_b32 s5, s77, 7
    v_add_u32 v6, s5, v6
    v_and_b32 v7, 31, v0
    v_lshrrev_b32 v8, 5, v0
    s_and_b32 s5, s4, 3
    s_lshl_b32 s5, s5, 6
    v_add_u32 v9, s5, v7
    v_lshrrev_b32 v18, 1, v9
    v_and_b32 v18, 7, v18
    v_lshlrev_b32 v9, 7, v9
    v_add_u32 v19, 0, v8
    v_xor_b32 v19, v19, v18
    v_lshl_add_u32 v10, v19, 4, v9
    v_add_u32 v19, 2, v8
    v_xor_b32 v19, v19, v18
    v_lshl_add_u32 v12, v19, 4, v9
    v_add_u32 v19, 4, v8
    v_xor_b32 v19, v19, v18
    v_lshl_add_u32 v14, v19, 4, v9
    v_add_u32 v19, 6, v8
    v_xor_b32 v19, v19, v18
    v_lshl_add_u32 v16, v19, 4, v9
    v_add_u32 v9, s5, v7
    v_add_u32 v9, 32, v9
    v_lshrrev_b32 v18, 1, v9
    v_and_b32 v18, 7, v18
    v_lshlrev_b32 v9, 7, v9
    v_add_u32 v19, 0, v8
    v_xor_b32 v19, v19, v18
    v_lshl_add_u32 v11, v19, 4, v9
    v_add_u32 v19, 2, v8
    v_xor_b32 v19, v19, v18
    v_lshl_add_u32 v13, v19, 4, v9
    v_add_u32 v19, 4, v8
    v_xor_b32 v19, v19, v18
    v_lshl_add_u32 v15, v19, 4, v9
    v_add_u32 v19, 6, v8
    v_xor_b32 v19, v19, v18
    v_lshl_add_u32 v17, v19, 4, v9
    v_and_b32 v7, 15, v0
    v_lshrrev_b32 v8, 2, v7
    v_and_b32 v7, 3, v7
    v_lshrrev_b32 v9, 4, v0
    v_lshrrev_b32 v19, 1, v9
    v_lshl_add_u32 v19, v19, 3, v8
    v_lshlrev_b32 v19, 7, v19
    v_and_b32 v9, 1, v9
    v_lshl_add_u32 v19, v9, 5, v19
    v_lshl_add_u32 v19, v7, 3, v19
    v_lshrrev_b32 v8, 1, v8
    v_and_b32 v8, 1, v8
    s_lshr_b32 s5, s4, 2
    v_xor_b32 v8, s5, v8
    v_lshl_add_u32 v18, v8, 6, v19
    v_mov_b32 v128, 0
    v_mov_b32 v129, 0
    v_mov_b32 v130, 0
    v_mov_b32 v131, 0
    v_mov_b32 v132, 0
    v_mov_b32 v133, 0
    v_mov_b32 v134, 0
    v_mov_b32 v135, 0
    v_mov_b32 v136, 0
    v_mov_b32 v137, 0
    v_mov_b32 v138, 0
    v_mov_b32 v139, 0
    v_mov_b32 v140, 0
    v_mov_b32 v141, 0
    v_mov_b32 v142, 0
    v_mov_b32 v143, 0
    v_mov_b32 v144, 0
    v_mov_b32 v145, 0
    v_mov_b32 v146, 0
    v_mov_b32 v147, 0
    v_mov_b32 v148, 0
    v_mov_b32 v149, 0
    v_mov_b32 v150, 0
    v_mov_b32 v151, 0
    v_mov_b32 v152, 0
    v_mov_b32 v153, 0
    v_mov_b32 v154, 0
    v_mov_b32 v155, 0
    v_mov_b32 v156, 0
    v_mov_b32 v157, 0
    v_mov_b32 v158, 0
    v_mov_b32 v159, 0
    v_mov_b32 v160, 0
    v_mov_b32 v161, 0
    v_mov_b32 v162, 0
    v_mov_b32 v163, 0
    v_mov_b32 v164, 0
    v_mov_b32 v165, 0
    v_mov_b32 v166, 0
    v_mov_b32 v167, 0
    v_mov_b32 v168, 0
    v_mov_b32 v169, 0
    v_mov_b32 v170, 0
    v_mov_b32 v171, 0
    v_mov_b32 v172, 0
    v_mov_b32 v173, 0
    v_mov_b32 v174, 0
    v_mov_b32 v175, 0
    v_mov_b32 v176, 0
    v_mov_b32 v177, 0
    v_mov_b32 v178, 0
    v_mov_b32 v179, 0
    v_mov_b32 v180, 0
    v_mov_b32 v181, 0
    v_mov_b32 v182, 0
    v_mov_b32 v183, 0
    v_mov_b32 v184, 0
    v_mov_b32 v185, 0
    v_mov_b32 v186, 0
    v_mov_b32 v187, 0
    v_mov_b32 v188, 0
    v_mov_b32 v189, 0
    v_mov_b32 v190, 0
    v_mov_b32 v191, 0
    s_mov_b32 s81, 0
    s_mov_b32 s82, 0
    s_lshl_b32 s5, s4, 12
    s_add_u32 m0, s5, 0
    s_nop 0
    buffer_load_dwordx4 v2, s[48:51], s81 offen lds
    s_add_u32 m0, s5, 1024
    s_nop 0
    buffer_load_dwordx4 v3, s[48:51], s81 offen lds
    s_add_u32 m0, s5, 2048
    s_nop 0
    buffer_load_dwordx4 v4, s[48:51], s81 offen lds
    s_add_u32 m0, s5, 3072
    s_nop 0
    buffer_load_dwordx4 v5, s[48:51], s81 offen lds
    s_lshl_b32 s5, s4, 10
    s_add_u32 m0, s5, 32768
    s_nop 0
    buffer_load_dwordx4 v6, s[32:35], s82 offen lds
    s_add_u32 m0, s5, 40960
    s_nop 0
    buffer_load_dwordx4 v6, s[36:39], s82 offen lds
    s_mov_b32 s81, 128
    s_mov_b32 s82, 221184
    s_lshl_b32 s5, s4, 12
    s_add_u32 m0, s5, 49152
    s_nop 0
    buffer_load_dwordx4 v2, s[48:51], s81 offen lds
    s_add_u32 m0, s5, 50176
    s_nop 0
    buffer_load_dwordx4 v3, s[48:51], s81 offen lds
    s_add_u32 m0, s5, 51200
    s_nop 0
    buffer_load_dwordx4 v4, s[48:51], s81 offen lds
    s_add_u32 m0, s5, 52224
    s_nop 0
    buffer_load_dwordx4 v5, s[48:51], s81 offen lds
    s_lshl_b32 s5, s4, 10
    s_add_u32 m0, s5, 81920
    s_nop 0
    buffer_load_dwordx4 v6, s[32:35], s82 offen lds
    s_add_u32 m0, s5, 90112
    s_nop 0
    buffer_load_dwordx4 v6, s[36:39], s82 offen lds
    s_waitcnt vmcnt(6)
    s_barrier
    s_mov_b32 s81, 256
    s_mov_b32 s82, 442368
    s_lshl_b32 s5, s4, 12
    s_add_u32 m0, s5, 98304
    s_nop 0
    buffer_load_dwordx4 v2, s[48:51], s81 offen lds
    s_add_u32 m0, s5, 99328
    s_nop 0
    buffer_load_dwordx4 v3, s[48:51], s81 offen lds
    s_add_u32 m0, s5, 100352
    s_nop 0
    buffer_load_dwordx4 v4, s[48:51], s81 offen lds
    s_add_u32 m0, s5, 101376
    s_nop 0
    buffer_load_dwordx4 v5, s[48:51], s81 offen lds
    s_lshl_b32 s5, s4, 10
    s_add_u32 m0, s5, 131072
    s_nop 0
    buffer_load_dwordx4 v6, s[32:35], s82 offen lds
    s_add_u32 m0, s5, 139264
    s_nop 0
    buffer_load_dwordx4 v6, s[36:39], s82 offen lds
    v_add_u32 v20, 0, v10
    v_add_u32 v21, 0, v11
    v_add_u32 v22, 0, v12
    v_add_u32 v23, 0, v13
    v_add_u32 v24, 0, v14
    v_add_u32 v25, 0, v15
    v_add_u32 v26, 0, v16
    v_add_u32 v27, 0, v17
    v_add_u32 v28, 0, v18
    ds_read_b64_tr_b16 v[100:101], v28 offset:32768
    ds_read_b64_tr_b16 v[102:103], v28 offset:33280
    ds_read_b64_tr_b16 v[104:105], v28 offset:40960
    ds_read_b64_tr_b16 v[106:107], v28 offset:41472
    ds_read_b128 v[116:119], v20
    ds_read_b128 v[120:123], v21
    ds_read_b64_tr_b16 v[108:109], v28 offset:34816
    ds_read_b64_tr_b16 v[110:111], v28 offset:35328
    ds_read_b64_tr_b16 v[112:113], v28 offset:43008
    ds_read_b64_tr_b16 v[114:115], v28 offset:43520
    ds_read_b128 v[192:195], v22
    ds_read_b128 v[196:199], v23
    s_waitcnt lgkmcnt(6)
    v_mfma_f32_32x32x16_bf16 v[128:143], v[100:103], v[116:119], v[128:143]
    v_mfma_f32_32x32x16_bf16 v[144:159], v[100:103], v[120:123], v[144:159]
    v_mfma_f32_32x32x16_bf16 v[160:175], v[104:107], v[116:119], v[160:175]
    v_mfma_f32_32x32x16_bf16 v[176:191], v[104:107], v[120:123], v[176:191]
    ds_read_b64_tr_b16 v[100:101], v28 offset:36864
    ds_read_b64_tr_b16 v[102:103], v28 offset:37376
    ds_read_b64_tr_b16 v[104:105], v28 offset:45056
    ds_read_b64_tr_b16 v[106:107], v28 offset:45568
    ds_read_b128 v[116:119], v24
    ds_read_b128 v[120:123], v25
    s_waitcnt lgkmcnt(6)
    v_mfma_f32_32x32x16_bf16 v[128:143], v[108:111], v[192:195], v[128:143]
    v_mfma_f32_32x32x16_bf16 v[144:159], v[108:111], v[196:199], v[144:159]
    v_mfma_f32_32x32x16_bf16 v[160:175], v[112:115], v[192:195], v[160:175]
    v_mfma_f32_32x32x16_bf16 v[176:191], v[112:115], v[196:199], v[176:191]
    ds_read_b64_tr_b16 v[108:109], v28 offset:38912
    ds_read_b64_tr_b16 v[110:111], v28 offset:39424
    ds_read_b64_tr_b16 v[112:113], v28 offset:47104
    ds_read_b64_tr_b16 v[114:115], v28 offset:47616
    ds_read_b128 v[192:195], v26
    ds_read_b128 v[196:199], v27
    s_waitcnt lgkmcnt(6)
    v_mfma_f32_32x32x16_bf16 v[128:143], v[100:103], v[116:119], v[128:143]
    v_mfma_f32_32x32x16_bf16 v[144:159], v[100:103], v[120:123], v[144:159]
    v_mfma_f32_32x32x16_bf16 v[160:175], v[104:107], v[116:119], v[160:175]
    v_mfma_f32_32x32x16_bf16 v[176:191], v[104:107], v[120:123], v[176:191]
    s_waitcnt lgkmcnt(0)
    v_mfma_f32_32x32x16_bf16 v[128:143], v[108:111], v[192:195], v[128:143]
    v_mfma_f32_32x32x16_bf16 v[144:159], v[108:111], v[196:199], v[144:159]
    v_mfma_f32_32x32x16_bf16 v[160:175], v[112:115], v[192:195], v[160:175]
    v_mfma_f32_32x32x16_bf16 v[176:191], v[112:115], v[196:199], v[176:191]
    s_waitcnt vmcnt(6)
    s_barrier
    s_mov_b32 s81, 384
    s_mov_b32 s82, 663552
    s_lshl_b32 s5, s4, 12
    s_add_u32 m0, s5, 0
    s_nop 0
    buffer_load_dwordx4 v2, s[48:51], s81 offen lds
    s_add_u32 m0, s5, 1024
    s_nop 0
    buffer_load_dwordx4 v3, s[48:51], s81 offen lds
    s_add_u32 m0, s5, 2048
    s_nop 0
    buffer_load_dwordx4 v4, s[48:51], s81 offen lds
    s_add_u32 m0, s5, 3072
    s_nop 0
    buffer_load_dwordx4 v5, s[48:51], s81 offen lds
    s_lshl_b32 s5, s4, 10
    s_add_u32 m0, s5, 32768
    s_nop 0
    buffer_load_dwordx4 v6, s[32:35], s82 offen lds
    s_add_u32 m0, s5, 40960
    s_nop 0
    buffer_load_dwordx4 v6, s[36:39], s82 offen lds
    v_add_u32 v20, 49152, v10
    v_add_u32 v21, 49152, v11
    v_add_u32 v22, 49152, v12
    v_add_u32 v23, 49152, v13
    v_add_u32 v24, 49152, v14
    v_add_u32 v25, 49152, v15
    v_add_u32 v26, 49152, v16
    v_add_u32 v27, 49152, v17
    v_add_u32 v28, 49152, v18
    ds_read_b64_tr_b16 v[100:101], v28 offset:32768
    ds_read_b64_tr_b16 v[102:103], v28 offset:33280
    ds_read_b64_tr_b16 v[104:105], v28 offset:40960
    ds_read_b64_tr_b16 v[106:107], v28 offset:41472
    ds_read_b128 v[116:119], v20
    ds_read_b128 v[120:123], v21
    ds_read_b64_tr_b16 v[108:109], v28 offset:34816
    ds_read_b64_tr_b16 v[110:111], v28 offset:35328
    ds_read_b64_tr_b16 v[112:113], v28 offset:43008
    ds_read_b64_tr_b16 v[114:115], v28 offset:43520
    ds_read_b128 v[192:195], v22
    ds_read_b128 v[196:199], v23
    s_waitcnt lgkmcnt(6)
    v_mfma_f32_32x32x16_bf16 v[128:143], v[100:103], v[116:119], v[128:143]
    v_mfma_f32_32x32x16_bf16 v[144:159], v[100:103], v[120:123], v[144:159]
    v_mfma_f32_32x32x16_bf16 v[160:175], v[104:107], v[116:119], v[160:175]
    v_mfma_f32_32x32x16_bf16 v[176:191], v[104:107], v[120:123], v[176:191]
    ds_read_b64_tr_b16 v[100:101], v28 offset:36864
    ds_read_b64_tr_b16 v[102:103], v28 offset:37376
    ds_read_b64_tr_b16 v[104:105], v28 offset:45056
    ds_read_b64_tr_b16 v[106:107], v28 offset:45568
    ds_read_b128 v[116:119], v24
    ds_read_b128 v[120:123], v25
    s_waitcnt lgkmcnt(6)
    v_mfma_f32_32x32x16_bf16 v[128:143], v[108:111], v[192:195], v[128:143]
    v_mfma_f32_32x32x16_bf16 v[144:159], v[108:111], v[196:199], v[144:159]
    v_mfma_f32_32x32x16_bf16 v[160:175], v[112:115], v[192:195], v[160:175]
    v_mfma_f32_32x32x16_bf16 v[176:191], v[112:115], v[196:199], v[176:191]
    ds_read_b64_tr_b16 v[108:109], v28 offset:38912
    ds_read_b64_tr_b16 v[110:111], v28 offset:39424
    ds_read_b64_tr_b16 v[112:113], v28 offset:47104
    ds_read_b64_tr_b16 v[114:115], v28 offset:47616
    ds_read_b128 v[192:195], v26
    ds_read_b128 v[196:199], v27
    s_waitcnt lgkmcnt(6)
    v_mfma_f32_32x32x16_bf16 v[128:143], v[100:103], v[116:119], v[128:143]
    v_mfma_f32_32x32x16_bf16 v[144:159], v[100:103], v[120:123], v[144:159]
    v_mfma_f32_32x32x16_bf16 v[160:175], v[104:107], v[116:119], v[160:175]
    v_mfma_f32_32x32x16_bf16 v[176:191], v[104:107], v[120:123], v[176:191]
    s_waitcnt lgkmcnt(0)
    v_mfma_f32_32x32x16_bf16 v[128:143], v[108:111], v[192:195], v[128:143]
    v_mfma_f32_32x32x16_bf16 v[144:159], v[108:111], v[196:199], v[144:159]
    v_mfma_f32_32x32x16_bf16 v[160:175], v[112:115], v[192:195], v[160:175]
    v_mfma_f32_32x32x16_bf16 v[176:191], v[112:115], v[196:199], v[176:191]
    s_waitcnt vmcnt(6)
    s_barrier
    s_mov_b32 s81, 512
    s_mov_b32 s82, 884736
    s_lshl_b32 s5, s4, 12
    s_add_u32 m0, s5, 49152
    s_nop 0
    buffer_load_dwordx4 v2, s[48:51], s81 offen lds
    s_add_u32 m0, s5, 50176
    s_nop 0
    buffer_load_dwordx4 v3, s[48:51], s81 offen lds
    s_add_u32 m0, s5, 51200
    s_nop 0
    buffer_load_dwordx4 v4, s[48:51], s81 offen lds
    s_add_u32 m0, s5, 52224
    s_nop 0
    buffer_load_dwordx4 v5, s[48:51], s81 offen lds
    s_lshl_b32 s5, s4, 10
    s_add_u32 m0, s5, 81920
    s_nop 0
    buffer_load_dwordx4 v6, s[32:35], s82 offen lds
    s_add_u32 m0, s5, 90112
    s_nop 0
    buffer_load_dwordx4 v6, s[36:39], s82 offen lds
    v_add_u32 v20, 98304, v10
    v_add_u32 v21, 98304, v11
    v_add_u32 v22, 98304, v12
    v_add_u32 v23, 98304, v13
    v_add_u32 v24, 98304, v14
    v_add_u32 v25, 98304, v15
    v_add_u32 v26, 98304, v16
    v_add_u32 v27, 98304, v17
    v_add_u32 v28, 98304, v18
    ds_read_b64_tr_b16 v[100:101], v28 offset:32768
    ds_read_b64_tr_b16 v[102:103], v28 offset:33280
    ds_read_b64_tr_b16 v[104:105], v28 offset:40960
    ds_read_b64_tr_b16 v[106:107], v28 offset:41472
    ds_read_b128 v[116:119], v20
    ds_read_b128 v[120:123], v21
    ds_read_b64_tr_b16 v[108:109], v28 offset:34816
    ds_read_b64_tr_b16 v[110:111], v28 offset:35328
    ds_read_b64_tr_b16 v[112:113], v28 offset:43008
    ds_read_b64_tr_b16 v[114:115], v28 offset:43520
    ds_read_b128 v[192:195], v22
    ds_read_b128 v[196:199], v23
    s_waitcnt lgkmcnt(6)
    v_mfma_f32_32x32x16_bf16 v[128:143], v[100:103], v[116:119], v[128:143]
    v_mfma_f32_32x32x16_bf16 v[144:159], v[100:103], v[120:123], v[144:159]
    v_mfma_f32_32x32x16_bf16 v[160:175], v[104:107], v[116:119], v[160:175]
    v_mfma_f32_32x32x16_bf16 v[176:191], v[104:107], v[120:123], v[176:191]
    ds_read_b64_tr_b16 v[100:101], v28 offset:36864
    ds_read_b64_tr_b16 v[102:103], v28 offset:37376
    ds_read_b64_tr_b16 v[104:105], v28 offset:45056
    ds_read_b64_tr_b16 v[106:107], v28 offset:45568
    ds_read_b128 v[116:119], v24
    ds_read_b128 v[120:123], v25
    s_waitcnt lgkmcnt(6)
    v_mfma_f32_32x32x16_bf16 v[128:143], v[108:111], v[192:195], v[128:143]
    v_mfma_f32_32x32x16_bf16 v[144:159], v[108:111], v[196:199], v[144:159]
    v_mfma_f32_32x32x16_bf16 v[160:175], v[112:115], v[192:195], v[160:175]
    v_mfma_f32_32x32x16_bf16 v[176:191], v[112:115], v[196:199], v[176:191]
    ds_read_b64_tr_b16 v[108:109], v28 offset:38912
    ds_read_b64_tr_b16 v[110:111], v28 offset:39424
    ds_read_b64_tr_b16 v[112:113], v28 offset:47104
    ds_read_b64_tr_b16 v[114:115], v28 offset:47616
    ds_read_b128 v[192:195], v26
    ds_read_b128 v[196:199], v27
    s_waitcnt lgkmcnt(6)
    v_mfma_f32_32x32x16_bf16 v[128:143], v[100:103], v[116:119], v[128:143]
    v_mfma_f32_32x32x16_bf16 v[144:159], v[100:103], v[120:123], v[144:159]
    v_mfma_f32_32x32x16_bf16 v[160:175], v[104:107], v[116:119], v[160:175]
    v_mfma_f32_32x32x16_bf16 v[176:191], v[104:107], v[120:123], v[176:191]
    s_waitcnt lgkmcnt(0)
    v_mfma_f32_32x32x16_bf16 v[128:143], v[108:111], v[192:195], v[128:143]
    v_mfma_f32_32x32x16_bf16 v[144:159], v[108:111], v[196:199], v[144:159]
    v_mfma_f32_32x32x16_bf16 v[160:175], v[112:115], v[192:195], v[160:175]
    v_mfma_f32_32x32x16_bf16 v[176:191], v[112:115], v[196:199], v[176:191]
    s_waitcnt vmcnt(6)
    s_barrier
    s_mov_b32 s81, 640
    s_mov_b32 s82, 1105920
    s_lshl_b32 s5, s4, 12
    s_add_u32 m0, s5, 98304
    s_nop 0
    buffer_load_dwordx4 v2, s[48:51], s81 offen lds
    s_add_u32 m0, s5, 99328
    s_nop 0
    buffer_load_dwordx4 v3, s[48:51], s81 offen lds
    s_add_u32 m0, s5, 100352
    s_nop 0
    buffer_load_dwordx4 v4, s[48:51], s81 offen lds
    s_add_u32 m0, s5, 101376
    s_nop 0
    buffer_load_dwordx4 v5, s[48:51], s81 offen lds
    s_lshl_b32 s5, s4, 10
    s_add_u32 m0, s5, 131072
    s_nop 0
    buffer_load_dwordx4 v6, s[32:35], s82 offen lds
    s_add_u32 m0, s5, 139264
    s_nop 0
    buffer_load_dwordx4 v6, s[36:39], s82 offen lds
    v_add_u32 v20, 0, v10
    v_add_u32 v21, 0, v11
    v_add_u32 v22, 0, v12
    v_add_u32 v23, 0, v13
    v_add_u32 v24, 0, v14
    v_add_u32 v25, 0, v15
    v_add_u32 v26, 0, v16
    v_add_u32 v27, 0, v17
    v_add_u32 v28, 0, v18
    ds_read_b64_tr_b16 v[100:101], v28 offset:32768
    ds_read_b64_tr_b16 v[102:103], v28 offset:33280
    ds_read_b64_tr_b16 v[104:105], v28 offset:40960
    ds_read_b64_tr_b16 v[106:107], v28 offset:41472
    ds_read_b128 v[116:119], v20
    ds_read_b128 v[120:123], v21
    ds_read_b64_tr_b16 v[108:109], v28 offset:34816
    ds_read_b64_tr_b16 v[110:111], v28 offset:35328
    ds_read_b64_tr_b16 v[112:113], v28 offset:43008
    ds_read_b64_tr_b16 v[114:115], v28 offset:43520
    ds_read_b128 v[192:195], v22
    ds_read_b128 v[196:199], v23
    s_waitcnt lgkmcnt(6)
    v_mfma_f32_32x32x16_bf16 v[128:143], v[100:103], v[116:119], v[128:143]
    v_mfma_f32_32x32x16_bf16 v[144:159], v[100:103], v[120:123], v[144:159]
    v_mfma_f32_32x32x16_bf16 v[160:175], v[104:107], v[116:119], v[160:175]
    v_mfma_f32_32x32x16_bf16 v[176:191], v[104:107], v[120:123], v[176:191]
    ds_read_b64_tr_b16 v[100:101], v28 offset:36864
    ds_read_b64_tr_b16 v[102:103], v28 offset:37376
    ds_read_b64_tr_b16 v[104:105], v28 offset:45056
    ds_read_b64_tr_b16 v[106:107], v28 offset:45568
    ds_read_b128 v[116:119], v24
    ds_read_b128 v[120:123], v25
    s_waitcnt lgkmcnt(6)
    v_mfma_f32_32x32x16_bf16 v[128:143], v[108:111], v[192:195], v[128:143]
    v_mfma_f32_32x32x16_bf16 v[144:159], v[108:111], v[196:199], v[144:159]
    v_mfma_f32_32x32x16_bf16 v[160:175], v[112:115], v[192:195], v[160:175]
    v_mfma_f32_32x32x16_bf16 v[176:191], v[112:115], v[196:199], v[176:191]
    ds_read_b64_tr_b16 v[108:109], v28 offset:38912
    ds_read_b64_tr_b16 v[110:111], v28 offset:39424
    ds_read_b64_tr_b16 v[112:113], v28 offset:47104
    ds_read_b64_tr_b16 v[114:115], v28 offset:47616
    ds_read_b128 v[192:195], v26
    ds_read_b128 v[196:199], v27
    s_waitcnt lgkmcnt(6)
    v_mfma_f32_32x32x16_bf16 v[128:143], v[100:103], v[116:119], v[128:143]
    v_mfma_f32_32x32x16_bf16 v[144:159], v[100:103], v[120:123], v[144:159]
    v_mfma_f32_32x32x16_bf16 v[160:175], v[104:107], v[116:119], v[160:175]
    v_mfma_f32_32x32x16_bf16 v[176:191], v[104:107], v[120:123], v[176:191]
    s_waitcnt lgkmcnt(0)
    v_mfma_f32_32x32x16_bf16 v[128:143], v[108:111], v[192:195], v[128:143]
    v_mfma_f32_32x32x16_bf16 v[144:159], v[108:111], v[196:199], v[144:159]
    v_mfma_f32_32x32x16_bf16 v[160:175], v[112:115], v[192:195], v[160:175]
    v_mfma_f32_32x32x16_bf16 v[176:191], v[112:115], v[196:199], v[176:191]
    s_waitcnt vmcnt(6)
    s_barrier
    s_mov_b32 s81, 768
    s_mov_b32 s82, 1327104
    s_lshl_b32 s5, s4, 12
    s_add_u32 m0, s5, 0
    s_nop 0
    buffer_load_dwordx4 v2, s[48:51], s81 offen lds
    s_add_u32 m0, s5, 1024
    s_nop 0
    buffer_load_dwordx4 v3, s[48:51], s81 offen lds
    s_add_u32 m0, s5, 2048
    s_nop 0
    buffer_load_dwordx4 v4, s[48:51], s81 offen lds
    s_add_u32 m0, s5, 3072
    s_nop 0
    buffer_load_dwordx4 v5, s[48:51], s81 offen lds
    s_lshl_b32 s5, s4, 10
    s_add_u32 m0, s5, 32768
    s_nop 0
    buffer_load_dwordx4 v6, s[32:35], s82 offen lds
    s_add_u32 m0, s5, 40960
    s_nop 0
    buffer_load_dwordx4 v6, s[36:39], s82 offen lds
    v_add_u32 v20, 49152, v10
    v_add_u32 v21, 49152, v11
    v_add_u32 v22, 49152, v12
    v_add_u32 v23, 49152, v13
    v_add_u32 v24, 49152, v14
    v_add_u32 v25, 49152, v15
    v_add_u32 v26, 49152, v16
    v_add_u32 v27, 49152, v17
    v_add_u32 v28, 49152, v18
    ds_read_b64_tr_b16 v[100:101], v28 offset:32768
    ds_read_b64_tr_b16 v[102:103], v28 offset:33280
    ds_read_b64_tr_b16 v[104:105], v28 offset:40960
    ds_read_b64_tr_b16 v[106:107], v28 offset:41472
    ds_read_b128 v[116:119], v20
    ds_read_b128 v[120:123], v21
    ds_read_b64_tr_b16 v[108:109], v28 offset:34816
    ds_read_b64_tr_b16 v[110:111], v28 offset:35328
    ds_read_b64_tr_b16 v[112:113], v28 offset:43008
    ds_read_b64_tr_b16 v[114:115], v28 offset:43520
    ds_read_b128 v[192:195], v22
    ds_read_b128 v[196:199], v23
    s_waitcnt lgkmcnt(6)
    v_mfma_f32_32x32x16_bf16 v[128:143], v[100:103], v[116:119], v[128:143]
    v_mfma_f32_32x32x16_bf16 v[144:159], v[100:103], v[120:123], v[144:159]
    v_mfma_f32_32x32x16_bf16 v[160:175], v[104:107], v[116:119], v[160:175]
    v_mfma_f32_32x32x16_bf16 v[176:191], v[104:107], v[120:123], v[176:191]
    ds_read_b64_tr_b16 v[100:101], v28 offset:36864
    ds_read_b64_tr_b16 v[102:103], v28 offset:37376
    ds_read_b64_tr_b16 v[104:105], v28 offset:45056
    ds_read_b64_tr_b16 v[106:107], v28 offset:45568
    ds_read_b128 v[116:119], v24
    ds_read_b128 v[120:123], v25
    s_waitcnt lgkmcnt(6)
    v_mfma_f32_32x32x16_bf16 v[128:143], v[108:111], v[192:195], v[128:143]
    v_mfma_f32_32x32x16_bf16 v[144:159], v[108:111], v[196:199], v[144:159]
    v_mfma_f32_32x32x16_bf16 v[160:175], v[112:115], v[192:195], v[160:175]
    v_mfma_f32_32x32x16_bf16 v[176:191], v[112:115], v[196:199], v[176:191]
    ds_read_b64_tr_b16 v[108:109], v28 offset:38912
    ds_read_b64_tr_b16 v[110:111], v28 offset:39424
    ds_read_b64_tr_b16 v[112:113], v28 offset:47104
    ds_read_b64_tr_b16 v[114:115], v28 offset:47616
    ds_read_b128 v[192:195], v26
    ds_read_b128 v[196:199], v27
    s_waitcnt lgkmcnt(6)
    v_mfma_f32_32x32x16_bf16 v[128:143], v[100:103], v[116:119], v[128:143]
    v_mfma_f32_32x32x16_bf16 v[144:159], v[100:103], v[120:123], v[144:159]
    v_mfma_f32_32x32x16_bf16 v[160:175], v[104:107], v[116:119], v[160:175]
    v_mfma_f32_32x32x16_bf16 v[176:191], v[104:107], v[120:123], v[176:191]
    s_waitcnt lgkmcnt(0)
    v_mfma_f32_32x32x16_bf16 v[128:143], v[108:111], v[192:195], v[128:143]
    v_mfma_f32_32x32x16_bf16 v[144:159], v[108:111], v[196:199], v[144:159]
    v_mfma_f32_32x32x16_bf16 v[160:175], v[112:115], v[192:195], v[160:175]
    v_mfma_f32_32x32x16_bf16 v[176:191], v[112:115], v[196:199], v[176:191]
    s_waitcnt vmcnt(6)
    s_barrier
    s_mov_b32 s81, 896
    s_mov_b32 s82, 1548288
    s_lshl_b32 s5, s4, 12
    s_add_u32 m0, s5, 49152
    s_nop 0
    buffer_load_dwordx4 v2, s[48:51], s81 offen lds
    s_add_u32 m0, s5, 50176
    s_nop 0
    buffer_load_dwordx4 v3, s[48:51], s81 offen lds
    s_add_u32 m0, s5, 51200
    s_nop 0
    buffer_load_dwordx4 v4, s[48:51], s81 offen lds
    s_add_u32 m0, s5, 52224
    s_nop 0
    buffer_load_dwordx4 v5, s[48:51], s81 offen lds
    s_lshl_b32 s5, s4, 10
    s_add_u32 m0, s5, 81920
    s_nop 0
    buffer_load_dwordx4 v6, s[32:35], s82 offen lds
    s_add_u32 m0, s5, 90112
    s_nop 0
    buffer_load_dwordx4 v6, s[36:39], s82 offen lds
    v_add_u32 v20, 98304, v10
    v_add_u32 v21, 98304, v11
    v_add_u32 v22, 98304, v12
    v_add_u32 v23, 98304, v13
    v_add_u32 v24, 98304, v14
    v_add_u32 v25, 98304, v15
    v_add_u32 v26, 98304, v16
    v_add_u32 v27, 98304, v17
    v_add_u32 v28, 98304, v18
    ds_read_b64_tr_b16 v[100:101], v28 offset:32768
    ds_read_b64_tr_b16 v[102:103], v28 offset:33280
    ds_read_b64_tr_b16 v[104:105], v28 offset:40960
    ds_read_b64_tr_b16 v[106:107], v28 offset:41472
    ds_read_b128 v[116:119], v20
    ds_read_b128 v[120:123], v21
    ds_read_b64_tr_b16 v[108:109], v28 offset:34816
    ds_read_b64_tr_b16 v[110:111], v28 offset:35328
    ds_read_b64_tr_b16 v[112:113], v28 offset:43008
    ds_read_b64_tr_b16 v[114:115], v28 offset:43520
    ds_read_b128 v[192:195], v22
    ds_read_b128 v[196:199], v23
    s_waitcnt lgkmcnt(6)
    v_mfma_f32_32x32x16_bf16 v[128:143], v[100:103], v[116:119], v[128:143]
    v_mfma_f32_32x32x16_bf16 v[144:159], v[100:103], v[120:123], v[144:159]
    v_mfma_f32_32x32x16_bf16 v[160:175], v[104:107], v[116:119], v[160:175]
    v_mfma_f32_32x32x16_bf16 v[176:191], v[104:107], v[120:123], v[176:191]
    ds_read_b64_tr_b16 v[100:101], v28 offset:36864
    ds_read_b64_tr_b16 v[102:103], v28 offset:37376
    ds_read_b64_tr_b16 v[104:105], v28 offset:45056
    ds_read_b64_tr_b16 v[106:107], v28 offset:45568
    ds_read_b128 v[116:119], v24
    ds_read_b128 v[120:123], v25
    s_waitcnt lgkmcnt(6)
    v_mfma_f32_32x32x16_bf16 v[128:143], v[108:111], v[192:195], v[128:143]
    v_mfma_f32_32x32x16_bf16 v[144:159], v[108:111], v[196:199], v[144:159]
    v_mfma_f32_32x32x16_bf16 v[160:175], v[112:115], v[192:195], v[160:175]
    v_mfma_f32_32x32x16_bf16 v[176:191], v[112:115], v[196:199], v[176:191]
    ds_read_b64_tr_b16 v[108:109], v28 offset:38912
    ds_read_b64_tr_b16 v[110:111], v28 offset:39424
    ds_read_b64_tr_b16 v[112:113], v28 offset:47104
    ds_read_b64_tr_b16 v[114:115], v28 offset:47616
    ds_read_b128 v[192:195], v26
    ds_read_b128 v[196:199], v27
    s_waitcnt lgkmcnt(6)
    v_mfma_f32_32x32x16_bf16 v[128:143], v[100:103], v[116:119], v[128:143]
    v_mfma_f32_32x32x16_bf16 v[144:159], v[100:103], v[120:123], v[144:159]
    v_mfma_f32_32x32x16_bf16 v[160:175], v[104:107], v[116:119], v[160:175]
    v_mfma_f32_32x32x16_bf16 v[176:191], v[104:107], v[120:123], v[176:191]
    s_waitcnt lgkmcnt(0)
    v_mfma_f32_32x32x16_bf16 v[128:143], v[108:111], v[192:195], v[128:143]
    v_mfma_f32_32x32x16_bf16 v[144:159], v[108:111], v[196:199], v[144:159]
    v_mfma_f32_32x32x16_bf16 v[160:175], v[112:115], v[192:195], v[160:175]
    v_mfma_f32_32x32x16_bf16 v[176:191], v[112:115], v[196:199], v[176:191]
    s_waitcnt vmcnt(6)
    s_barrier
    s_mov_b32 s81, 1024
    s_mov_b32 s82, 1769472
    s_lshl_b32 s5, s4, 12
    s_add_u32 m0, s5, 98304
    s_nop 0
    buffer_load_dwordx4 v2, s[48:51], s81 offen lds
    s_add_u32 m0, s5, 99328
    s_nop 0
    buffer_load_dwordx4 v3, s[48:51], s81 offen lds
    s_add_u32 m0, s5, 100352
    s_nop 0
    buffer_load_dwordx4 v4, s[48:51], s81 offen lds
    s_add_u32 m0, s5, 101376
    s_nop 0
    buffer_load_dwordx4 v5, s[48:51], s81 offen lds
    s_lshl_b32 s5, s4, 10
    s_add_u32 m0, s5, 131072
    s_nop 0
    buffer_load_dwordx4 v6, s[32:35], s82 offen lds
    s_add_u32 m0, s5, 139264
    s_nop 0
    buffer_load_dwordx4 v6, s[36:39], s82 offen lds
    v_add_u32 v20, 0, v10
    v_add_u32 v21, 0, v11
    v_add_u32 v22, 0, v12
    v_add_u32 v23, 0, v13
    v_add_u32 v24, 0, v14
    v_add_u32 v25, 0, v15
    v_add_u32 v26, 0, v16
    v_add_u32 v27, 0, v17
    v_add_u32 v28, 0, v18
    ds_read_b64_tr_b16 v[100:101], v28 offset:32768
    ds_read_b64_tr_b16 v[102:103], v28 offset:33280
    ds_read_b64_tr_b16 v[104:105], v28 offset:40960
    ds_read_b64_tr_b16 v[106:107], v28 offset:41472
    ds_read_b128 v[116:119], v20
    ds_read_b128 v[120:123], v21
    ds_read_b64_tr_b16 v[108:109], v28 offset:34816
    ds_read_b64_tr_b16 v[110:111], v28 offset:35328
    ds_read_b64_tr_b16 v[112:113], v28 offset:43008
    ds_read_b64_tr_b16 v[114:115], v28 offset:43520
    ds_read_b128 v[192:195], v22
    ds_read_b128 v[196:199], v23
    s_waitcnt lgkmcnt(6)
    v_mfma_f32_32x32x16_bf16 v[128:143], v[100:103], v[116:119], v[128:143]
    v_mfma_f32_32x32x16_bf16 v[144:159], v[100:103], v[120:123], v[144:159]
    v_mfma_f32_32x32x16_bf16 v[160:175], v[104:107], v[116:119], v[160:175]
    v_mfma_f32_32x32x16_bf16 v[176:191], v[104:107], v[120:123], v[176:191]
    ds_read_b64_tr_b16 v[100:101], v28 offset:36864
    ds_read_b64_tr_b16 v[102:103], v28 offset:37376
    ds_read_b64_tr_b16 v[104:105], v28 offset:45056
    ds_read_b64_tr_b16 v[106:107], v28 offset:45568
    ds_read_b128 v[116:119], v24
    ds_read_b128 v[120:123], v25
    s_waitcnt lgkmcnt(6)
    v_mfma_f32_32x32x16_bf16 v[128:143], v[108:111], v[192:195], v[128:143]
    v_mfma_f32_32x32x16_bf16 v[144:159], v[108:111], v[196:199], v[144:159]
    v_mfma_f32_32x32x16_bf16 v[160:175], v[112:115], v[192:195], v[160:175]
    v_mfma_f32_32x32x16_bf16 v[176:191], v[112:115], v[196:199], v[176:191]
    ds_read_b64_tr_b16 v[108:109], v28 offset:38912
    ds_read_b64_tr_b16 v[110:111], v28 offset:39424
    ds_read_b64_tr_b16 v[112:113], v28 offset:47104
    ds_read_b64_tr_b16 v[114:115], v28 offset:47616
    ds_read_b128 v[192:195], v26
    ds_read_b128 v[196:199], v27
    s_waitcnt lgkmcnt(6)
    v_mfma_f32_32x32x16_bf16 v[128:143], v[100:103], v[116:119], v[128:143]
    v_mfma_f32_32x32x16_bf16 v[144:159], v[100:103], v[120:123], v[144:159]
    v_mfma_f32_32x32x16_bf16 v[160:175], v[104:107], v[116:119], v[160:175]
    v_mfma_f32_32x32x16_bf16 v[176:191], v[104:107], v[120:123], v[176:191]
    s_waitcnt lgkmcnt(0)
    v_mfma_f32_32x32x16_bf16 v[128:143], v[108:111], v[192:195], v[128:143]
    v_mfma_f32_32x32x16_bf16 v[144:159], v[108:111], v[196:199], v[144:159]
    v_mfma_f32_32x32x16_bf16 v[160:175], v[112:115], v[192:195], v[160:175]
    v_mfma_f32_32x32x16_bf16 v[176:191], v[112:115], v[196:199], v[176:191]
    s_waitcnt vmcnt(6)
    s_barrier
    s_mov_b32 s81, 1152
    s_mov_b32 s82, 1990656
    s_lshl_b32 s5, s4, 12
    s_add_u32 m0, s5, 0
    s_nop 0
    buffer_load_dwordx4 v2, s[48:51], s81 offen lds
    s_add_u32 m0, s5, 1024
    s_nop 0
    buffer_load_dwordx4 v3, s[48:51], s81 offen lds
    s_add_u32 m0, s5, 2048
    s_nop 0
    buffer_load_dwordx4 v4, s[48:51], s81 offen lds
    s_add_u32 m0, s5, 3072
    s_nop 0
    buffer_load_dwordx4 v5, s[48:51], s81 offen lds
    s_lshl_b32 s5, s4, 10
    s_add_u32 m0, s5, 32768
    s_nop 0
    buffer_load_dwordx4 v6, s[32:35], s82 offen lds
    s_add_u32 m0, s5, 40960
    s_nop 0
    buffer_load_dwordx4 v6, s[36:39], s82 offen lds
    v_add_u32 v20, 49152, v10
    v_add_u32 v21, 49152, v11
    v_add_u32 v22, 49152, v12
    v_add_u32 v23, 49152, v13
    v_add_u32 v24, 49152, v14
    v_add_u32 v25, 49152, v15
    v_add_u32 v26, 49152, v16
    v_add_u32 v27, 49152, v17
    v_add_u32 v28, 49152, v18
    ds_read_b64_tr_b16 v[100:101], v28 offset:32768
    ds_read_b64_tr_b16 v[102:103], v28 offset:33280
    ds_read_b64_tr_b16 v[104:105], v28 offset:40960
    ds_read_b64_tr_b16 v[106:107], v28 offset:41472
    ds_read_b128 v[116:119], v20
    ds_read_b128 v[120:123], v21
    ds_read_b64_tr_b16 v[108:109], v28 offset:34816
    ds_read_b64_tr_b16 v[110:111], v28 offset:35328
    ds_read_b64_tr_b16 v[112:113], v28 offset:43008
    ds_read_b64_tr_b16 v[114:115], v28 offset:43520
    ds_read_b128 v[192:195], v22
    ds_read_b128 v[196:199], v23
    s_waitcnt lgkmcnt(6)
    v_mfma_f32_32x32x16_bf16 v[128:143], v[100:103], v[116:119], v[128:143]
    v_mfma_f32_32x32x16_bf16 v[144:159], v[100:103], v[120:123], v[144:159]
    v_mfma_f32_32x32x16_bf16 v[160:175], v[104:107], v[116:119], v[160:175]
    v_mfma_f32_32x32x16_bf16 v[176:191], v[104:107], v[120:123], v[176:191]
    ds_read_b64_tr_b16 v[100:101], v28 offset:36864
    ds_read_b64_tr_b16 v[102:103], v28 offset:37376
    ds_read_b64_tr_b16 v[104:105], v28 offset:45056
    ds_read_b64_tr_b16 v[106:107], v28 offset:45568
    ds_read_b128 v[116:119], v24
    ds_read_b128 v[120:123], v25
    s_waitcnt lgkmcnt(6)
    v_mfma_f32_32x32x16_bf16 v[128:143], v[108:111], v[192:195], v[128:143]
    v_mfma_f32_32x32x16_bf16 v[144:159], v[108:111], v[196:199], v[144:159]
    v_mfma_f32_32x32x16_bf16 v[160:175], v[112:115], v[192:195], v[160:175]
    v_mfma_f32_32x32x16_bf16 v[176:191], v[112:115], v[196:199], v[176:191]
    ds_read_b64_tr_b16 v[108:109], v28 offset:38912
    ds_read_b64_tr_b16 v[110:111], v28 offset:39424
    ds_read_b64_tr_b16 v[112:113], v28 offset:47104
    ds_read_b64_tr_b16 v[114:115], v28 offset:47616
    ds_read_b128 v[192:195], v26
    ds_read_b128 v[196:199], v27
    s_waitcnt lgkmcnt(6)
    v_mfma_f32_32x32x16_bf16 v[128:143], v[100:103], v[116:119], v[128:143]
    v_mfma_f32_32x32x16_bf16 v[144:159], v[100:103], v[120:123], v[144:159]
    v_mfma_f32_32x32x16_bf16 v[160:175], v[104:107], v[116:119], v[160:175]
    v_mfma_f32_32x32x16_bf16 v[176:191], v[104:107], v[120:123], v[176:191]
    s_waitcnt lgkmcnt(0)
    v_mfma_f32_32x32x16_bf16 v[128:143], v[108:111], v[192:195], v[128:143]
    v_mfma_f32_32x32x16_bf16 v[144:159], v[108:111], v[196:199], v[144:159]
    v_mfma_f32_32x32x16_bf16 v[160:175], v[112:115], v[192:195], v[160:175]
    v_mfma_f32_32x32x16_bf16 v[176:191], v[112:115], v[196:199], v[176:191]
    s_waitcnt vmcnt(6)
    s_barrier
    v_add_u32 v20, 98304, v10
    v_add_u32 v21, 98304, v11
    v_add_u32 v22, 98304, v12
    v_add_u32 v23, 98304, v13
    v_add_u32 v24, 98304, v14
    v_add_u32 v25, 98304, v15
    v_add_u32 v26, 98304, v16
    v_add_u32 v27, 98304, v17
    v_add_u32 v28, 98304, v18
    ds_read_b64_tr_b16 v[100:101], v28 offset:32768
    ds_read_b64_tr_b16 v[102:103], v28 offset:33280
    ds_read_b64_tr_b16 v[104:105], v28 offset:40960
    ds_read_b64_tr_b16 v[106:107], v28 offset:41472
    ds_read_b128 v[116:119], v20
    ds_read_b128 v[120:123], v21
    ds_read_b64_tr_b16 v[108:109], v28 offset:34816
    ds_read_b64_tr_b16 v[110:111], v28 offset:35328
    ds_read_b64_tr_b16 v[112:113], v28 offset:43008
    ds_read_b64_tr_b16 v[114:115], v28 offset:43520
    ds_read_b128 v[192:195], v22
    ds_read_b128 v[196:199], v23
    s_waitcnt lgkmcnt(6)
    v_mfma_f32_32x32x16_bf16 v[128:143], v[100:103], v[116:119], v[128:143]
    v_mfma_f32_32x32x16_bf16 v[144:159], v[100:103], v[120:123], v[144:159]
    v_mfma_f32_32x32x16_bf16 v[160:175], v[104:107], v[116:119], v[160:175]
    v_mfma_f32_32x32x16_bf16 v[176:191], v[104:107], v[120:123], v[176:191]
    ds_read_b64_tr_b16 v[100:101], v28 offset:36864
    ds_read_b64_tr_b16 v[102:103], v28 offset:37376
    ds_read_b64_tr_b16 v[104:105], v28 offset:45056
    ds_read_b64_tr_b16 v[106:107], v28 offset:45568
    ds_read_b128 v[116:119], v24
    ds_read_b128 v[120:123], v25
    s_waitcnt lgkmcnt(6)
    v_mfma_f32_32x32x16_bf16 v[128:143], v[108:111], v[192:195], v[128:143]
    v_mfma_f32_32x32x16_bf16 v[144:159], v[108:111], v[196:199], v[144:159]
    v_mfma_f32_32x32x16_bf16 v[160:175], v[112:115], v[192:195], v[160:175]
    v_mfma_f32_32x32x16_bf16 v[176:191], v[112:115], v[196:199], v[176:191]
    ds_read_b64_tr_b16 v[108:109], v28 offset:38912
    ds_read_b64_tr_b16 v[110:111], v28 offset:39424
    ds_read_b64_tr_b16 v[112:113], v28 offset:47104
    ds_read_b64_tr_b16 v[114:115], v28 offset:47616
    ds_read_b128 v[192:195], v26
    ds_read_b128 v[196:199], v27
    s_waitcnt lgkmcnt(6)
    v_mfma_f32_32x32x16_bf16 v[128:143], v[100:103], v[116:119], v[128:143]
    v_mfma_f32_32x32x16_bf16 v[144:159], v[100:103], v[120:123], v[144:159]
    v_mfma_f32_32x32x16_bf16 v[160:175], v[104:107], v[116:119], v[160:175]
    v_mfma_f32_32x32x16_bf16 v[176:191], v[104:107], v[120:123], v[176:191]
    s_waitcnt lgkmcnt(0)
    v_mfma_f32_32x32x16_bf16 v[128:143], v[108:111], v[192:195], v[128:143]
    v_mfma_f32_32x32x16_bf16 v[144:159], v[108:111], v[196:199], v[144:159]
    v_mfma_f32_32x32x16_bf16 v[160:175], v[112:115], v[192:195], v[160:175]
    v_mfma_f32_32x32x16_bf16 v[176:191], v[112:115], v[196:199], v[176:191]
    s_waitcnt vmcnt(0)
    s_barrier
    v_add_u32 v20, 0, v10
    v_add_u32 v21, 0, v11
    v_add_u32 v22, 0, v12
    v_add_u32 v23, 0, v13
    v_add_u32 v24, 0, v14
    v_add_u32 v25, 0, v15
    v_add_u32 v26, 0, v16
    v_add_u32 v27, 0, v17
    v_add_u32 v28, 0, v18
    ds_read_b64_tr_b16 v[100:101], v28 offset:32768
    ds_read_b64_tr_b16 v[102:103], v28 offset:33280
    ds_read_b64_tr_b16 v[104:105], v28 offset:40960
    ds_read_b64_tr_b16 v[106:107], v28 offset:41472
    ds_read_b128 v[116:119], v20
    ds_read_b128 v[120:123], v21
    ds_read_b64_tr_b16 v[108:109], v28 offset:34816
    ds_read_b64_tr_b16 v[110:111], v28 offset:35328
    ds_read_b64_tr_b16 v[112:113], v28 offset:43008
    ds_read_b64_tr_b16 v[114:115], v28 offset:43520
    ds_read_b128 v[192:195], v22
    ds_read_b128 v[196:199], v23
    s_waitcnt lgkmcnt(6)
    v_mfma_f32_32x32x16_bf16 v[128:143], v[100:103], v[116:119], v[128:143]
    v_mfma_f32_32x32x16_bf16 v[144:159], v[100:103], v[120:123], v[144:159]
    v_mfma_f32_32x32x16_bf16 v[160:175], v[104:107], v[116:119], v[160:175]
    v_mfma_f32_32x32x16_bf16 v[176:191], v[104:107], v[120:123], v[176:191]
    ds_read_b64_tr_b16 v[100:101], v28 offset:36864
    ds_read_b64_tr_b16 v[102:103], v28 offset:37376
    ds_read_b64_tr_b16 v[104:105], v28 offset:45056
    ds_read_b64_tr_b16 v[106:107], v28 offset:45568
    ds_read_b128 v[116:119], v24
    ds_read_b128 v[120:123], v25
    s_waitcnt lgkmcnt(6)
    v_mfma_f32_32x32x16_bf16 v[128:143], v[108:111], v[192:195], v[128:143]
    v_mfma_f32_32x32x16_bf16 v[144:159], v[108:111], v[196:199], v[144:159]
    v_mfma_f32_32x32x16_bf16 v[160:175], v[112:115], v[192:195], v[160:175]
    v_mfma_f32_32x32x16_bf16 v[176:191], v[112:115], v[196:199], v[176:191]
    ds_read_b64_tr_b16 v[108:109], v28 offset:38912
    ds_read_b64_tr_b16 v[110:111], v28 offset:39424
    ds_read_b64_tr_b16 v[112:113], v28 offset:47104
    ds_read_b64_tr_b16 v[114:115], v28 offset:47616
    ds_read_b128 v[192:195], v26
    ds_read_b128 v[196:199], v27
    s_waitcnt lgkmcnt(6)
    v_mfma_f32_32x32x16_bf16 v[128:143], v[100:103], v[116:119], v[128:143]
    v_mfma_f32_32x32x16_bf16 v[144:159], v[100:103], v[120:123], v[144:159]
    v_mfma_f32_32x32x16_bf16 v[160:175], v[104:107], v[116:119], v[160:175]
    v_mfma_f32_32x32x16_bf16 v[176:191], v[104:107], v[120:123], v[176:191]
    s_waitcnt lgkmcnt(0)
    v_mfma_f32_32x32x16_bf16 v[128:143], v[108:111], v[192:195], v[128:143]
    v_mfma_f32_32x32x16_bf16 v[144:159], v[108:111], v[196:199], v[144:159]
    v_mfma_f32_32x32x16_bf16 v[160:175], v[112:115], v[192:195], v[160:175]
    v_mfma_f32_32x32x16_bf16 v[176:191], v[112:115], v[196:199], v[176:191]
    s_nop 7
    s_nop 7
    v_and_b32 v7, 31, v0
    v_lshrrev_b32 v8, 5, v0
    s_and_b32 s5, s4, 3
    s_lshl_b32 s5, s5, 6
    s_lshl_b32 s6, s76, 8
    s_add_u32 s5, s5, s6
    s_lshl_b32 s6, s77, 1
    s_lshr_b32 s7, s4, 2
    s_add_u32 s6, s6, s7
    v_add_u32 v9, s5, v7
    v_lshrrev_b32 v10, 4, v9
    s_mov_b32 s7, 54
    v_mul_lo_u32 v10, v10, s7
    v_add_u32 v10, s6, v10
    v_lshlrev_b32 v10, 10, v10
    v_and_b32 v9, 15, v9
    v_lshl_add_u32 v10, v9, 4, v10
    v_lshl_add_u32 v10, v8, 3, v10
    v_add_u32 v10, 6291456, v10
    v_cvt_pk_bf16_f32 v11, v128, v129
    v_lshlrev_b32 v128, 16, v11
    v_and_b32 v129, 0xffff0000, v11
    v_cvt_pk_bf16_f32 v11, v130, v131
    v_lshlrev_b32 v130, 16, v11
    v_and_b32 v131, 0xffff0000, v11
    v_cvt_pk_bf16_f32 v11, v160, v161
    v_lshlrev_b32 v160, 16, v11
    v_and_b32 v161, 0xffff0000, v11
    v_cvt_pk_bf16_f32 v11, v162, v163
    v_lshlrev_b32 v162, 16, v11
    v_and_b32 v163, 0xffff0000, v11
    v_mul_f32 v128, 0xbfb8aa3b, v128
    v_mul_f32 v129, 0xbfb8aa3b, v129
    v_mul_f32 v130, 0xbfb8aa3b, v130
    v_mul_f32 v131, 0xbfb8aa3b, v131
    v_exp_f32 v128, v128
    v_exp_f32 v129, v129
    v_exp_f32 v130, v130
    v_exp_f32 v131, v131
    v_add_f32 v128, 1.0, v128
    v_add_f32 v129, 1.0, v129
    v_add_f32 v130, 1.0, v130
    v_add_f32 v131, 1.0, v131
    v_rcp_f32 v128, v128
    v_rcp_f32 v129, v129
    v_rcp_f32 v130, v130
    v_rcp_f32 v131, v131
    s_nop 0
    v_cvt_pk_bf16_f32 v11, v128, v129
    v_lshlrev_b32 v128, 16, v11
    v_and_b32 v129, 0xffff0000, v11
    v_cvt_pk_bf16_f32 v11, v130, v131
    v_lshlrev_b32 v130, 16, v11
    v_and_b32 v131, 0xffff0000, v11
    v_mul_f32 v128, v128, v160
    v_mul_f32 v129, v129, v161
    v_mul_f32 v130, v130, v162
    v_mul_f32 v131, v131, v163
    v_cvt_pk_bf16_f32 v12, v128, v129
    v_cvt_pk_bf16_f32 v13, v130, v131
    buffer_store_dwordx2 v[12:13], v10, s[48:51], 0 offen offset:0
    v_cvt_pk_bf16_f32 v11, v132, v133
    v_lshlrev_b32 v132, 16, v11
    v_and_b32 v133, 0xffff0000, v11
    v_cvt_pk_bf16_f32 v11, v134, v135
    v_lshlrev_b32 v134, 16, v11
    v_and_b32 v135, 0xffff0000, v11
    v_cvt_pk_bf16_f32 v11, v164, v165
    v_lshlrev_b32 v164, 16, v11
    v_and_b32 v165, 0xffff0000, v11
    v_cvt_pk_bf16_f32 v11, v166, v167
    v_lshlrev_b32 v166, 16, v11
    v_and_b32 v167, 0xffff0000, v11
    v_mul_f32 v132, 0xbfb8aa3b, v132
    v_mul_f32 v133, 0xbfb8aa3b, v133
    v_mul_f32 v134, 0xbfb8aa3b, v134
    v_mul_f32 v135, 0xbfb8aa3b, v135
    v_exp_f32 v132, v132
    v_exp_f32 v133, v133
    v_exp_f32 v134, v134
    v_exp_f32 v135, v135
    v_add_f32 v132, 1.0, v132
    v_add_f32 v133, 1.0, v133
    v_add_f32 v134, 1.0, v134
    v_add_f32 v135, 1.0, v135
    v_rcp_f32 v132, v132
    v_rcp_f32 v133, v133
    v_rcp_f32 v134, v134
    v_rcp_f32 v135, v135
    s_nop 0
    v_cvt_pk_bf16_f32 v11, v132, v133
    v_lshlrev_b32 v132, 16, v11
    v_and_b32 v133, 0xffff0000, v11
    v_cvt_pk_bf16_f32 v11, v134, v135
    v_lshlrev_b32 v134, 16, v11
    v_and_b32 v135, 0xffff0000, v11
    v_mul_f32 v132, v132, v164
    v_mul_f32 v133, v133, v165
    v_mul_f32 v134, v134, v166
    v_mul_f32 v135, v135, v167
    v_cvt_pk_bf16_f32 v12, v132, v133
    v_cvt_pk_bf16_f32 v13, v134, v135
    buffer_store_dwordx2 v[12:13], v10, s[48:51], 0 offen offset:256
    v_cvt_pk_bf16_f32 v11, v136, v137
    v_lshlrev_b32 v136, 16, v11
    v_and_b32 v137, 0xffff0000, v11
    v_cvt_pk_bf16_f32 v11, v138, v139
    v_lshlrev_b32 v138, 16, v11
    v_and_b32 v139, 0xffff0000, v11
    v_cvt_pk_bf16_f32 v11, v168, v169
    v_lshlrev_b32 v168, 16, v11
    v_and_b32 v169, 0xffff0000, v11
    v_cvt_pk_bf16_f32 v11, v170, v171
    v_lshlrev_b32 v170, 16, v11
    v_and_b32 v171, 0xffff0000, v11
    v_mul_f32 v136, 0xbfb8aa3b, v136
    v_mul_f32 v137, 0xbfb8aa3b, v137
    v_mul_f32 v138, 0xbfb8aa3b, v138
    v_mul_f32 v139, 0xbfb8aa3b, v139
    v_exp_f32 v136, v136
    v_exp_f32 v137, v137
    v_exp_f32 v138, v138
    v_exp_f32 v139, v139
    v_add_f32 v136, 1.0, v136
    v_add_f32 v137, 1.0, v137
    v_add_f32 v138, 1.0, v138
    v_add_f32 v139, 1.0, v139
    v_rcp_f32 v136, v136
    v_rcp_f32 v137, v137
    v_rcp_f32 v138, v138
    v_rcp_f32 v139, v139
    s_nop 0
    v_cvt_pk_bf16_f32 v11, v136, v137
    v_lshlrev_b32 v136, 16, v11
    v_and_b32 v137, 0xffff0000, v11
    v_cvt_pk_bf16_f32 v11, v138, v139
    v_lshlrev_b32 v138, 16, v11
    v_and_b32 v139, 0xffff0000, v11
    v_mul_f32 v136, v136, v168
    v_mul_f32 v137, v137, v169
    v_mul_f32 v138, v138, v170
    v_mul_f32 v139, v139, v171
    v_cvt_pk_bf16_f32 v12, v136, v137
    v_cvt_pk_bf16_f32 v13, v138, v139
    buffer_store_dwordx2 v[12:13], v10, s[48:51], 0 offen offset:512
    v_cvt_pk_bf16_f32 v11, v140, v141
    v_lshlrev_b32 v140, 16, v11
    v_and_b32 v141, 0xffff0000, v11
    v_cvt_pk_bf16_f32 v11, v142, v143
    v_lshlrev_b32 v142, 16, v11
    v_and_b32 v143, 0xffff0000, v11
    v_cvt_pk_bf16_f32 v11, v172, v173
    v_lshlrev_b32 v172, 16, v11
    v_and_b32 v173, 0xffff0000, v11
    v_cvt_pk_bf16_f32 v11, v174, v175
    v_lshlrev_b32 v174, 16, v11
    v_and_b32 v175, 0xffff0000, v11
    v_mul_f32 v140, 0xbfb8aa3b, v140
    v_mul_f32 v141, 0xbfb8aa3b, v141
    v_mul_f32 v142, 0xbfb8aa3b, v142
    v_mul_f32 v143, 0xbfb8aa3b, v143
    v_exp_f32 v140, v140
    v_exp_f32 v141, v141
    v_exp_f32 v142, v142
    v_exp_f32 v143, v143
    v_add_f32 v140, 1.0, v140
    v_add_f32 v141, 1.0, v141
    v_add_f32 v142, 1.0, v142
    v_add_f32 v143, 1.0, v143
    v_rcp_f32 v140, v140
    v_rcp_f32 v141, v141
    v_rcp_f32 v142, v142
    v_rcp_f32 v143, v143
    s_nop 0
    v_cvt_pk_bf16_f32 v11, v140, v141
    v_lshlrev_b32 v140, 16, v11
    v_and_b32 v141, 0xffff0000, v11
    v_cvt_pk_bf16_f32 v11, v142, v143
    v_lshlrev_b32 v142, 16, v11
    v_and_b32 v143, 0xffff0000, v11
    v_mul_f32 v140, v140, v172
    v_mul_f32 v141, v141, v173
    v_mul_f32 v142, v142, v174
    v_mul_f32 v143, v143, v175
    v_cvt_pk_bf16_f32 v12, v140, v141
    v_cvt_pk_bf16_f32 v13, v142, v143
    buffer_store_dwordx2 v[12:13], v10, s[48:51], 0 offen offset:768
    v_add_u32 v9, s5, v7
    v_add_u32 v9, 32, v9
    v_lshrrev_b32 v10, 4, v9
    s_mov_b32 s7, 54
    v_mul_lo_u32 v10, v10, s7
    v_add_u32 v10, s6, v10
    v_lshlrev_b32 v10, 10, v10
    v_and_b32 v9, 15, v9
    v_lshl_add_u32 v10, v9, 4, v10
    v_lshl_add_u32 v10, v8, 3, v10
    v_add_u32 v10, 6291456, v10
    v_cvt_pk_bf16_f32 v11, v144, v145
    v_lshlrev_b32 v144, 16, v11
    v_and_b32 v145, 0xffff0000, v11
    v_cvt_pk_bf16_f32 v11, v146, v147
    v_lshlrev_b32 v146, 16, v11
    v_and_b32 v147, 0xffff0000, v11
    v_cvt_pk_bf16_f32 v11, v176, v177
    v_lshlrev_b32 v176, 16, v11
    v_and_b32 v177, 0xffff0000, v11
    v_cvt_pk_bf16_f32 v11, v178, v179
    v_lshlrev_b32 v178, 16, v11
    v_and_b32 v179, 0xffff0000, v11
    v_mul_f32 v144, 0xbfb8aa3b, v144
    v_mul_f32 v145, 0xbfb8aa3b, v145
    v_mul_f32 v146, 0xbfb8aa3b, v146
    v_mul_f32 v147, 0xbfb8aa3b, v147
    v_exp_f32 v144, v144
    v_exp_f32 v145, v145
    v_exp_f32 v146, v146
    v_exp_f32 v147, v147
    v_add_f32 v144, 1.0, v144
    v_add_f32 v145, 1.0, v145
    v_add_f32 v146, 1.0, v146
    v_add_f32 v147, 1.0, v147
    v_rcp_f32 v144, v144
    v_rcp_f32 v145, v145
    v_rcp_f32 v146, v146
    v_rcp_f32 v147, v147
    s_nop 0
    v_cvt_pk_bf16_f32 v11, v144, v145
    v_lshlrev_b32 v144, 16, v11
    v_and_b32 v145, 0xffff0000, v11
    v_cvt_pk_bf16_f32 v11, v146, v147
    v_lshlrev_b32 v146, 16, v11
    v_and_b32 v147, 0xffff0000, v11
    v_mul_f32 v144, v144, v176
    v_mul_f32 v145, v145, v177
    v_mul_f32 v146, v146, v178
    v_mul_f32 v147, v147, v179
    v_cvt_pk_bf16_f32 v12, v144, v145
    v_cvt_pk_bf16_f32 v13, v146, v147
    buffer_store_dwordx2 v[12:13], v10, s[48:51], 0 offen offset:0
    v_cvt_pk_bf16_f32 v11, v148, v149
    v_lshlrev_b32 v148, 16, v11
    v_and_b32 v149, 0xffff0000, v11
    v_cvt_pk_bf16_f32 v11, v150, v151
    v_lshlrev_b32 v150, 16, v11
    v_and_b32 v151, 0xffff0000, v11
    v_cvt_pk_bf16_f32 v11, v180, v181
    v_lshlrev_b32 v180, 16, v11
    v_and_b32 v181, 0xffff0000, v11
    v_cvt_pk_bf16_f32 v11, v182, v183
    v_lshlrev_b32 v182, 16, v11
    v_and_b32 v183, 0xffff0000, v11
    v_mul_f32 v148, 0xbfb8aa3b, v148
    v_mul_f32 v149, 0xbfb8aa3b, v149
    v_mul_f32 v150, 0xbfb8aa3b, v150
    v_mul_f32 v151, 0xbfb8aa3b, v151
    v_exp_f32 v148, v148
    v_exp_f32 v149, v149
    v_exp_f32 v150, v150
    v_exp_f32 v151, v151
    v_add_f32 v148, 1.0, v148
    v_add_f32 v149, 1.0, v149
    v_add_f32 v150, 1.0, v150
    v_add_f32 v151, 1.0, v151
    v_rcp_f32 v148, v148
    v_rcp_f32 v149, v149
    v_rcp_f32 v150, v150
    v_rcp_f32 v151, v151
    s_nop 0
    v_cvt_pk_bf16_f32 v11, v148, v149
    v_lshlrev_b32 v148, 16, v11
    v_and_b32 v149, 0xffff0000, v11
    v_cvt_pk_bf16_f32 v11, v150, v151
    v_lshlrev_b32 v150, 16, v11
    v_and_b32 v151, 0xffff0000, v11
    v_mul_f32 v148, v148, v180
    v_mul_f32 v149, v149, v181
    v_mul_f32 v150, v150, v182
    v_mul_f32 v151, v151, v183
    v_cvt_pk_bf16_f32 v12, v148, v149
    v_cvt_pk_bf16_f32 v13, v150, v151
    buffer_store_dwordx2 v[12:13], v10, s[48:51], 0 offen offset:256
    v_cvt_pk_bf16_f32 v11, v152, v153
    v_lshlrev_b32 v152, 16, v11
    v_and_b32 v153, 0xffff0000, v11
    v_cvt_pk_bf16_f32 v11, v154, v155
    v_lshlrev_b32 v154, 16, v11
    v_and_b32 v155, 0xffff0000, v11
    v_cvt_pk_bf16_f32 v11, v184, v185
    v_lshlrev_b32 v184, 16, v11
    v_and_b32 v185, 0xffff0000, v11
    v_cvt_pk_bf16_f32 v11, v186, v187
    v_lshlrev_b32 v186, 16, v11
    v_and_b32 v187, 0xffff0000, v11
    v_mul_f32 v152, 0xbfb8aa3b, v152
    v_mul_f32 v153, 0xbfb8aa3b, v153
    v_mul_f32 v154, 0xbfb8aa3b, v154
    v_mul_f32 v155, 0xbfb8aa3b, v155
    v_exp_f32 v152, v152
    v_exp_f32 v153, v153
    v_exp_f32 v154, v154
    v_exp_f32 v155, v155
    v_add_f32 v152, 1.0, v152
    v_add_f32 v153, 1.0, v153
    v_add_f32 v154, 1.0, v154
    v_add_f32 v155, 1.0, v155
    v_rcp_f32 v152, v152
    v_rcp_f32 v153, v153
    v_rcp_f32 v154, v154
    v_rcp_f32 v155, v155
    s_nop 0
    v_cvt_pk_bf16_f32 v11, v152, v153
    v_lshlrev_b32 v152, 16, v11
    v_and_b32 v153, 0xffff0000, v11
    v_cvt_pk_bf16_f32 v11, v154, v155
    v_lshlrev_b32 v154, 16, v11
    v_and_b32 v155, 0xffff0000, v11
    v_mul_f32 v152, v152, v184
    v_mul_f32 v153, v153, v185
    v_mul_f32 v154, v154, v186
    v_mul_f32 v155, v155, v187
    v_cvt_pk_bf16_f32 v12, v152, v153
    v_cvt_pk_bf16_f32 v13, v154, v155
    buffer_store_dwordx2 v[12:13], v10, s[48:51], 0 offen offset:512
    v_cvt_pk_bf16_f32 v11, v156, v157
    v_lshlrev_b32 v156, 16, v11
    v_and_b32 v157, 0xffff0000, v11
    v_cvt_pk_bf16_f32 v11, v158, v159
    v_lshlrev_b32 v158, 16, v11
    v_and_b32 v159, 0xffff0000, v11
    v_cvt_pk_bf16_f32 v11, v188, v189
    v_lshlrev_b32 v188, 16, v11
    v_and_b32 v189, 0xffff0000, v11
    v_cvt_pk_bf16_f32 v11, v190, v191
    v_lshlrev_b32 v190, 16, v11
    v_and_b32 v191, 0xffff0000, v11
    v_mul_f32 v156, 0xbfb8aa3b, v156
    v_mul_f32 v157, 0xbfb8aa3b, v157
    v_mul_f32 v158, 0xbfb8aa3b, v158
    v_mul_f32 v159, 0xbfb8aa3b, v159
    v_exp_f32 v156, v156
    v_exp_f32 v157, v157
    v_exp_f32 v158, v158
    v_exp_f32 v159, v159
    v_add_f32 v156, 1.0, v156
    v_add_f32 v157, 1.0, v157
    v_add_f32 v158, 1.0, v158
    v_add_f32 v159, 1.0, v159
    v_rcp_f32 v156, v156
    v_rcp_f32 v157, v157
    v_rcp_f32 v158, v158
    v_rcp_f32 v159, v159
    s_nop 0
    v_cvt_pk_bf16_f32 v11, v156, v157
    v_lshlrev_b32 v156, 16, v11
    v_and_b32 v157, 0xffff0000, v11
    v_cvt_pk_bf16_f32 v11, v158, v159
    v_lshlrev_b32 v158, 16, v11
    v_and_b32 v159, 0xffff0000, v11
    v_mul_f32 v156, v156, v188
    v_mul_f32 v157, v157, v189
    v_mul_f32 v158, v158, v190
    v_mul_f32 v159, v159, v191
    v_cvt_pk_bf16_f32 v12, v156, v157
    v_cvt_pk_bf16_f32 v13, v158, v159
    buffer_store_dwordx2 v[12:13], v10, s[48:51], 0 offen offset:768
    s_waitcnt vmcnt(0)
    s_barrier
NOG1:
    s_lshr_b32 s76, s2, 1
    s_and_b32 s77, s2, 1
    s_mul_i32 s78, s76, 5
    s_mul_i32 s5, s77, 3
    s_add_u32 s79, s78, s5
    s_lshl_b32 s6, s4, 6
    v_add_u32 v1, s6, v0
    s_add_u32 s80, s79, 0
    v_cmp_gt_u32 vcc, 264, v1
    s_and_saveexec_b64 s[6:7], vcc
    s_cbranch_execz CV_K0
    v_sub_u32 v2, 255, v1
    v_lshlrev_b32 v2, 4, v2
    s_lshl_b32 s5, s80, 12
    v_mov_b32 v10, 0
    v_mov_b32 v11, 0
    v_mov_b32 v12, 0
    v_mov_b32 v13, 0
    v_mov_b32 v14, 0
    v_mov_b32 v15, 0
    v_mov_b32 v16, 0
    v_mov_b32 v17, 0
    v_cmp_le_i32 vcc, 0, v2
    s_and_saveexec_b64 s[82:83], vcc
    v_add_u32 v3, s5, v2
    buffer_load_dwordx4 v[10:13], v3, s[24:27], 0 offen
    s_mov_b64 exec, s[82:83]
    v_cmp_le_i32 vcc, -16, v2
    s_and_saveexec_b64 s[82:83], vcc
    v_add_u32 v3, s5, v2
    buffer_load_dwordx4 v[14:17], v3, s[24:27], 0 offen offset:16
    s_mov_b64 exec, s[82:83]
    v_lshlrev_b32 v4, 4, v1
    v_add_u32 v4, 0, v4
    s_waitcnt vmcnt(0)
    v_mov_b32 v20, v14
    v_mov_b32 v21, v15
    v_mov_b32 v22, v16
    v_mov_b32 v23, v17
    v_alignbit_b32 v24, v23, v23, 16
    v_alignbit_b32 v25, v22, v22, 16
    v_alignbit_b32 v26, v21, v21, 16
    v_alignbit_b32 v27, v20, v20, 16
    ds_write_b128 v4, v[24:27] offset:0
    v_alignbit_b32 v20, v14, v13, 16
    v_alignbit_b32 v21, v15, v14, 16
    v_alignbit_b32 v22, v16, v15, 16
    v_alignbit_b32 v23, v17, v16, 16
    v_alignbit_b32 v24, v23, v23, 16
    v_alignbit_b32 v25, v22, v22, 16
    v_alignbit_b32 v26, v21, v21, 16
    v_alignbit_b32 v27, v20, v20, 16
    ds_write_b128 v4, v[24:27] offset:4240
    v_mov_b32 v20, v13
    v_mov_b32 v21, v14
    v_mov_b32 v22, v15
    v_mov_b32 v23, v16
    v_alignbit_b32 v24, v23, v23, 16
    v_alignbit_b32 v25, v22, v22, 16
    v_alignbit_b32 v26, v21, v21, 16
    v_alignbit_b32 v27, v20, v20, 16
    ds_write_b128 v4, v[24:27] offset:8480
    v_alignbit_b32 v20, v13, v12, 16
    v_alignbit_b32 v21, v14, v13, 16
    v_alignbit_b32 v22, v15, v14, 16
    v_alignbit_b32 v23, v16, v15, 16
    v_alignbit_b32 v24, v23, v23, 16
    v_alignbit_b32 v25, v22, v22, 16
    v_alignbit_b32 v26, v21, v21, 16
    v_alignbit_b32 v27, v20, v20, 16
    ds_write_b128 v4, v[24:27] offset:12720
    v_mov_b32 v20, v12
    v_mov_b32 v21, v13
    v_mov_b32 v22, v14
    v_mov_b32 v23, v15
    v_alignbit_b32 v24, v23, v23, 16
    v_alignbit_b32 v25, v22, v22, 16
    v_alignbit_b32 v26, v21, v21, 16
    v_alignbit_b32 v27, v20, v20, 16
    ds_write_b128 v4, v[24:27] offset:16960
    v_alignbit_b32 v20, v12, v11, 16
    v_alignbit_b32 v21, v13, v12, 16
    v_alignbit_b32 v22, v14, v13, 16
    v_alignbit_b32 v23, v15, v14, 16
    v_alignbit_b32 v24, v23, v23, 16
    v_alignbit_b32 v25, v22, v22, 16
    v_alignbit_b32 v26, v21, v21, 16
    v_alignbit_b32 v27, v20, v20, 16
    ds_write_b128 v4, v[24:27] offset:21200
    v_mov_b32 v20, v11
    v_mov_b32 v21, v12
    v_mov_b32 v22, v13
    v_mov_b32 v23, v14
    v_alignbit_b32 v24, v23, v23, 16
    v_alignbit_b32 v25, v22, v22, 16
    v_alignbit_b32 v26, v21, v21, 16
    v_alignbit_b32 v27, v20, v20, 16
    ds_write_b128 v4, v[24:27] offset:25440
    v_alignbit_b32 v20, v11, v10, 16
    v_alignbit_b32 v21, v12, v11, 16
    v_alignbit_b32 v22, v13, v12, 16
    v_alignbit_b32 v23, v14, v13, 16
    v_alignbit_b32 v24, v23, v23, 16
    v_alignbit_b32 v25, v22, v22, 16
    v_alignbit_b32 v26, v21, v21, 16
    v_alignbit_b32 v27, v20, v20, 16
    ds_write_b128 v4, v[24:27] offset:29680
CV_K0:
    s_mov_b64 exec, s[6:7]
    v_cmp_le_u32 vcc, 256, v1
    s_and_saveexec_b64 s[6:7], vcc
    s_cbranch_execz CV_V0
    v_subrev_u32 v2, 256, v1
    s_lshl_b32 s5, s80, 12
    s_add_u32 s5, s5, 3145728
    v_lshlrev_b32 v3, 4, v2
    v_add_u32 v3, s5, v3
    buffer_load_dwordx4 v[10:13], v3, s[48:51], 0 offen
    v_lshrrev_b32 v4, 2, v2
    v_mul_u32_u24 v4, 80, v4
    v_and_b32 v5, 3, v2
    v_lshl_add_u32 v4, v5, 4, v4
    v_add_u32 v4, 0, v4
    v_mov_b32 v14, 0
    v_mov_b32 v15, 0
    v_mov_b32 v16, 0
    v_mov_b32 v17, 0
    v_cmp_gt_u32 vcc, 128, v2
    s_and_saveexec_b64 s[82:83], vcc
    ds_write_b128 v4, v[14:17] offset:33920
    s_mov_b64 exec, s[82:83]
    s_waitcnt vmcnt(0)
    ds_write_b128 v4, v[10:13] offset:36480
CV_V0:
    s_mov_b64 exec, s[6:7]
    s_add_u32 s80, s79, 1
    v_cmp_gt_u32 vcc, 264, v1
    s_and_saveexec_b64 s[6:7], vcc
    s_cbranch_execz CV_K1
    v_sub_u32 v2, 255, v1
    v_lshlrev_b32 v2, 4, v2
    s_lshl_b32 s5, s80, 12
    v_mov_b32 v10, 0
    v_mov_b32 v11, 0
    v_mov_b32 v12, 0
    v_mov_b32 v13, 0
    v_mov_b32 v14, 0
    v_mov_b32 v15, 0
    v_mov_b32 v16, 0
    v_mov_b32 v17, 0
    v_cmp_le_i32 vcc, 0, v2
    s_and_saveexec_b64 s[82:83], vcc
    v_add_u32 v3, s5, v2
    buffer_load_dwordx4 v[10:13], v3, s[24:27], 0 offen
    s_mov_b64 exec, s[82:83]
    v_cmp_le_i32 vcc, -16, v2
    s_and_saveexec_b64 s[82:83], vcc
    v_add_u32 v3, s5, v2
    buffer_load_dwordx4 v[14:17], v3, s[24:27], 0 offen offset:16
    s_mov_b64 exec, s[82:83]
    v_lshlrev_b32 v4, 4, v1
    v_add_u32 v4, 41600, v4
    s_waitcnt vmcnt(0)
    v_mov_b32 v20, v14
    v_mov_b32 v21, v15
    v_mov_b32 v22, v16
    v_mov_b32 v23, v17
    v_alignbit_b32 v24, v23, v23, 16
    v_alignbit_b32 v25, v22, v22, 16
    v_alignbit_b32 v26, v21, v21, 16
    v_alignbit_b32 v27, v20, v20, 16
    ds_write_b128 v4, v[24:27] offset:0
    v_alignbit_b32 v20, v14, v13, 16
    v_alignbit_b32 v21, v15, v14, 16
    v_alignbit_b32 v22, v16, v15, 16
    v_alignbit_b32 v23, v17, v16, 16
    v_alignbit_b32 v24, v23, v23, 16
    v_alignbit_b32 v25, v22, v22, 16
    v_alignbit_b32 v26, v21, v21, 16
    v_alignbit_b32 v27, v20, v20, 16
    ds_write_b128 v4, v[24:27] offset:4240
    v_mov_b32 v20, v13
    v_mov_b32 v21, v14
    v_mov_b32 v22, v15
    v_mov_b32 v23, v16
    v_alignbit_b32 v24, v23, v23, 16
    v_alignbit_b32 v25, v22, v22, 16
    v_alignbit_b32 v26, v21, v21, 16
    v_alignbit_b32 v27, v20, v20, 16
    ds_write_b128 v4, v[24:27] offset:8480
    v_alignbit_b32 v20, v13, v12, 16
    v_alignbit_b32 v21, v14, v13, 16
    v_alignbit_b32 v22, v15, v14, 16
    v_alignbit_b32 v23, v16, v15, 16
    v_alignbit_b32 v24, v23, v23, 16
    v_alignbit_b32 v25, v22, v22, 16
    v_alignbit_b32 v26, v21, v21, 16
    v_alignbit_b32 v27, v20, v20, 16
    ds_write_b128 v4, v[24:27] offset:12720
    v_mov_b32 v20, v12
    v_mov_b32 v21, v13
    v_mov_b32 v22, v14
    v_mov_b32 v23, v15
    v_alignbit_b32 v24, v23, v23, 16
    v_alignbit_b32 v25, v22, v22, 16
    v_alignbit_b32 v26, v21, v21, 16
    v_alignbit_b32 v27, v20, v20, 16
    ds_write_b128 v4, v[24:27] offset:16960
    v_alignbit_b32 v20, v12, v11, 16
    v_alignbit_b32 v21, v13, v12, 16
    v_alignbit_b32 v22, v14, v13, 16
    v_alignbit_b32 v23, v15, v14, 16
    v_alignbit_b32 v24, v23, v23, 16
    v_alignbit_b32 v25, v22, v22, 16
    v_alignbit_b32 v26, v21, v21, 16
    v_alignbit_b32 v27, v20, v20, 16
    ds_write_b128 v4, v[24:27] offset:21200
    v_mov_b32 v20, v11
    v_mov_b32 v21, v12
    v_mov_b32 v22, v13
    v_mov_b32 v23, v14
    v_alignbit_b32 v24, v23, v23, 16
    v_alignbit_b32 v25, v22, v22, 16
    v_alignbit_b32 v26, v21, v21, 16
    v_alignbit_b32 v27, v20, v20, 16
    ds_write_b128 v4, v[24:27] offset:25440
    v_alignbit_b32 v20, v11, v10, 16
    v_alignbit_b32 v21, v12, v11, 16
    v_alignbit_b32 v22, v13, v12, 16
    v_alignbit_b32 v23, v14, v13, 16
    v_alignbit_b32 v24, v23, v23, 16
    v_alignbit_b32 v25, v22, v22, 16
    v_alignbit_b32 v26, v21, v21, 16
    v_alignbit_b32 v27, v20, v20, 16
    ds_write_b128 v4, v[24:27] offset:29680
CV_K1:
    s_mov_b64 exec, s[6:7]
    v_cmp_le_u32 vcc, 256, v1
    s_and_saveexec_b64 s[6:7], vcc
    s_cbranch_execz CV_V1
    v_subrev_u32 v2, 256, v1
    s_lshl_b32 s5, s80, 12
    s_add_u32 s5, s5, 3145728
    v_lshlrev_b32 v3, 4, v2
    v_add_u32 v3, s5, v3
    buffer_load_dwordx4 v[10:13], v3, s[48:51], 0 offen
    v_lshrrev_b32 v4, 2, v2
    v_mul_u32_u24 v4, 80, v4
    v_and_b32 v5, 3, v2
    v_lshl_add_u32 v4, v5, 4, v4
    v_add_u32 v4, 41600, v4
    v_mov_b32 v14, 0
    v_mov_b32 v15, 0
    v_mov_b32 v16, 0
    v_mov_b32 v17, 0
    v_cmp_gt_u32 vcc, 128, v2
    s_and_saveexec_b64 s[82:83], vcc
    ds_write_b128 v4, v[14:17] offset:33920
    s_mov_b64 exec, s[82:83]
    s_waitcnt vmcnt(0)
    ds_write_b128 v4, v[10:13] offset:36480
CV_V1:
    s_mov_b64 exec, s[6:7]
    s_add_u32 s80, s78, 2
    v_cmp_gt_u32 vcc, 264, v1
    s_and_saveexec_b64 s[6:7], vcc
    s_cbranch_execz CV_K2
    v_sub_u32 v2, 255, v1
    v_lshlrev_b32 v2, 4, v2
    s_lshl_b32 s5, s80, 12
    v_mov_b32 v10, 0
    v_mov_b32 v11, 0
    v_mov_b32 v12, 0
    v_mov_b32 v13, 0
    v_mov_b32 v14, 0
    v_mov_b32 v15, 0
    v_mov_b32 v16, 0
    v_mov_b32 v17, 0
    v_cmp_le_i32 vcc, 0, v2
    s_and_saveexec_b64 s[82:83], vcc
    v_add_u32 v3, s5, v2
    buffer_load_dwordx4 v[10:13], v3, s[24:27], 0 offen
    s_mov_b64 exec, s[82:83]
    v_cmp_le_i32 vcc, -16, v2
    s_and_saveexec_b64 s[82:83], vcc
    v_add_u32 v3, s5, v2
    buffer_load_dwordx4 v[14:17], v3, s[24:27], 0 offen offset:16
    s_mov_b64 exec, s[82:83]
    v_lshlrev_b32 v4, 4, v1
    v_add_u32 v4, 83200, v4
    s_waitcnt vmcnt(0)
    v_mov_b32 v20, v14
    v_mov_b32 v21, v15
    v_mov_b32 v22, v16
    v_mov_b32 v23, v17
    v_alignbit_b32 v24, v23, v23, 16
    v_alignbit_b32 v25, v22, v22, 16
    v_alignbit_b32 v26, v21, v21, 16
    v_alignbit_b32 v27, v20, v20, 16
    ds_write_b128 v4, v[24:27] offset:0
    v_alignbit_b32 v20, v14, v13, 16
    v_alignbit_b32 v21, v15, v14, 16
    v_alignbit_b32 v22, v16, v15, 16
    v_alignbit_b32 v23, v17, v16, 16
    v_alignbit_b32 v24, v23, v23, 16
    v_alignbit_b32 v25, v22, v22, 16
    v_alignbit_b32 v26, v21, v21, 16
    v_alignbit_b32 v27, v20, v20, 16
    ds_write_b128 v4, v[24:27] offset:4240
    v_mov_b32 v20, v13
    v_mov_b32 v21, v14
    v_mov_b32 v22, v15
    v_mov_b32 v23, v16
    v_alignbit_b32 v24, v23, v23, 16
    v_alignbit_b32 v25, v22, v22, 16
    v_alignbit_b32 v26, v21, v21, 16
    v_alignbit_b32 v27, v20, v20, 16
    ds_write_b128 v4, v[24:27] offset:8480
    v_alignbit_b32 v20, v13, v12, 16
    v_alignbit_b32 v21, v14, v13, 16
    v_alignbit_b32 v22, v15, v14, 16
    v_alignbit_b32 v23, v16, v15, 16
    v_alignbit_b32 v24, v23, v23, 16
    v_alignbit_b32 v25, v22, v22, 16
    v_alignbit_b32 v26, v21, v21, 16
    v_alignbit_b32 v27, v20, v20, 16
    ds_write_b128 v4, v[24:27] offset:12720
    v_mov_b32 v20, v12
    v_mov_b32 v21, v13
    v_mov_b32 v22, v14
    v_mov_b32 v23, v15
    v_alignbit_b32 v24, v23, v23, 16
    v_alignbit_b32 v25, v22, v22, 16
    v_alignbit_b32 v26, v21, v21, 16
    v_alignbit_b32 v27, v20, v20, 16
    ds_write_b128 v4, v[24:27] offset:16960
    v_alignbit_b32 v20, v12, v11, 16
    v_alignbit_b32 v21, v13, v12, 16
    v_alignbit_b32 v22, v14, v13, 16
    v_alignbit_b32 v23, v15, v14, 16
    v_alignbit_b32 v24, v23, v23, 16
    v_alignbit_b32 v25, v22, v22, 16
    v_alignbit_b32 v26, v21, v21, 16
    v_alignbit_b32 v27, v20, v20, 16
    ds_write_b128 v4, v[24:27] offset:21200
    v_mov_b32 v20, v11
    v_mov_b32 v21, v12
    v_mov_b32 v22, v13
    v_mov_b32 v23, v14
    v_alignbit_b32 v24, v23, v23, 16
    v_alignbit_b32 v25, v22, v22, 16
    v_alignbit_b32 v26, v21, v21, 16
    v_alignbit_b32 v27, v20, v20, 16
    ds_write_b128 v4, v[24:27] offset:25440
    v_alignbit_b32 v20, v11, v10, 16
    v_alignbit_b32 v21, v12, v11, 16
    v_alignbit_b32 v22, v13, v12, 16
    v_alignbit_b32 v23, v14, v13, 16
    v_alignbit_b32 v24, v23, v23, 16
    v_alignbit_b32 v25, v22, v22, 16
    v_alignbit_b32 v26, v21, v21, 16
    v_alignbit_b32 v27, v20, v20, 16
    ds_write_b128 v4, v[24:27] offset:29680
CV_K2:
    s_mov_b64 exec, s[6:7]
    v_cmp_le_u32 vcc, 256, v1
    s_and_saveexec_b64 s[6:7], vcc
    s_cbranch_execz CV_V2
    v_subrev_u32 v2, 256, v1
    s_lshl_b32 s5, s80, 12
    s_add_u32 s5, s5, 3145728
    v_lshlrev_b32 v3, 4, v2
    v_add_u32 v3, s5, v3
    buffer_load_dwordx4 v[10:13], v3, s[48:51], 0 offen
    v_lshrrev_b32 v4, 2, v2
    v_mul_u32_u24 v4, 80, v4
    v_and_b32 v5, 3, v2
    v_lshl_add_u32 v4, v5, 4, v4
    v_add_u32 v4, 83200, v4
    v_mov_b32 v14, 0
    v_mov_b32 v15, 0
    v_mov_b32 v16, 0
    v_mov_b32 v17, 0
    v_cmp_gt_u32 vcc, 128, v2
    s_and_saveexec_b64 s[82:83], vcc
    ds_write_b128 v4, v[14:17] offset:33920
    s_mov_b64 exec, s[82:83]
    s_waitcnt vmcnt(0)
    ds_write_b128 v4, v[10:13] offset:36480
CV_V2:
    s_mov_b64 exec, s[6:7]
    s_waitcnt lgkmcnt(0)
    s_barrier
    s_mov_b32 s5, 21846
    s_mul_i32 s80, s4, s5
    s_lshr_b32 s80, s80, 16
    s_mul_i32 s5, s80, 3
    s_sub_u32 s81, s4, s5
    s_cmp_lt_u32 s4, 6
    s_cbranch_scc1 CV_T
    s_mov_b32 s80, 2
    s_sub_u32 s81, s4, 6
    s_add_u32 s81, s81, s77
    s_cmp_eq_u32 s77, 0
    s_cselect_b32 s5, 1, 0
    s_cmp_eq_u32 s4, 7
    s_cselect_b32 s6, 1, 0
    s_and_b32 s5, s5, s6
    s_cmp_eq_u32 s5, 1
    s_cbranch_scc0 CV_T
    s_mov_b32 s81, 3
CV_T:
    s_add_u32 s84, s79, s80
    s_add_u32 s5, s78, 2
    s_cmp_eq_u32 s80, 2
    s_cselect_b32 s84, s5, s84
    s_mul_i32 s85, s80, 41600
    s_min_u32 s86, s81, 1
    s_cmp_eq_u32 s81, 2
    s_cselect_b32 s87, 64, 32
    v_and_b32 v7, 31, v0
    v_lshrrev_b32 v8, 5, v0
    v_mov_b32 v128, 0
    v_mov_b32 v129, 0
    v_mov_b32 v130, 0
    v_mov_b32 v131, 0
    v_mov_b32 v132, 0
    v_mov_b32 v133, 0
    v_mov_b32 v134, 0
    v_mov_b32 v135, 0
    v_mov_b32 v136, 0
    v_mov_b32 v137, 0
    v_mov_b32 v138, 0
    v_mov_b32 v139, 0
    v_mov_b32 v140, 0
    v_mov_b32 v141, 0
    v_mov_b32 v142, 0
    v_mov_b32 v143, 0
    s_cmp_eq_u32 s81, 3
    s_cbranch_scc1 CV_RED
    v_sub_u32 v9, 2055, v7
    v_and_b32 v10, 7, v9
    v_sub_u32 v9, v9, v10
    v_lshl_add_u32 v9, v8, 3, v9
    v_lshlrev_b32 v9, 1, v9
    s_mov_b32 s5, 4240
    v_mul_lo_u32 v10, v10, s5
    v_add_u32 v9, v9, v10
    s_sub_u32 s5, s87, 1
    s_lshl_b32 s5, s5, 6
    s_sub_u32 s5, s85, s5
    v_add_u32 v9, s5, v9
    s_lshl_b32 s5, s86, 5
    s_add_u32 s5, s5, 33
    s_sub_u32 s5, s5, s87
    v_add_u32 v10, s5, v7
    v_mul_u32_u24 v10, 80, v10
    v_lshl_add_u32 v10, v8, 4, v10
    s_add_u32 s5, s85, 33920
    v_add_u32 v10, s5, v10
    ds_read_b128 v[100:103], v9 offset:0
    ds_read_b128 v[104:107], v10 offset:0
    ds_read_b128 v[108:111], v9 offset:32
    ds_read_b128 v[112:115], v10 offset:32
    ds_read_b128 v[116:119], v9 offset:64
    ds_read_b128 v[120:123], v10 offset:80
    s_waitcnt lgkmcnt(4)
    v_mfma_f32_32x32x16_bf16 v[128:143], v[100:103], v[104:107], v[128:143]
    ds_read_b128 v[100:103], v9 offset:96
    ds_read_b128 v[104:107], v10 offset:112
    s_waitcnt lgkmcnt(4)
    v_mfma_f32_32x32x16_bf16 v[128:143], v[108:111], v[112:115], v[128:143]
    ds_read_b128 v[108:111], v9 offset:128
    ds_read_b128 v[112:115], v10 offset:160
    s_waitcnt lgkmcnt(4)
    v_mfma_f32_32x32x16_bf16 v[128:143], v[116:119], v[120:123], v[128:143]
    ds_read_b128 v[116:119], v9 offset:160
    ds_read_b128 v[120:123], v10 offset:192
    s_waitcnt lgkmcnt(4)
    v_mfma_f32_32x32x16_bf16 v[128:143], v[100:103], v[104:107], v[128:143]
    ds_read_b128 v[100:103], v9 offset:192
    ds_read_b128 v[104:107], v10 offset:240
    s_waitcnt lgkmcnt(4)
    v_mfma_f32_32x32x16_bf16 v[128:143], v[108:111], v[112:115], v[128:143]
    ds_read_b128 v[108:111], v9 offset:224
    ds_read_b128 v[112:115], v10 offset:272
    s_waitcnt lgkmcnt(4)
    v_mfma_f32_32x32x16_bf16 v[128:143], v[116:119], v[120:123], v[128:143]
    ds_read_b128 v[116:119], v9 offset:256
    ds_read_b128 v[120:123], v10 offset:320
    s_waitcnt lgkmcnt(4)
    v_mfma_f32_32x32x16_bf16 v[128:143], v[100:103], v[104:107], v[128:143]
    ds_read_b128 v[100:103], v9 offset:288
    ds_read_b128 v[104:107], v10 offset:352
    s_waitcnt lgkmcnt(4)
    v_mfma_f32_32x32x16_bf16 v[128:143], v[108:111], v[112:115], v[128:143]
    ds_read_b128 v[108:111], v9 offset:320
    ds_read_b128 v[112:115], v10 offset:400
    s_waitcnt lgkmcnt(4)
    v_mfma_f32_32x32x16_bf16 v[128:143], v[116:119], v[120:123], v[128:143]
    ds_read_b128 v[116:119], v9 offset:352
    ds_read_b128 v[120:123], v10 offset:432
    s_waitcnt lgkmcnt(4)
    v_mfma_f32_32x32x16_bf16 v[128:143], v[100:103], v[104:107], v[128:143]
    ds_read_b128 v[100:103], v9 offset:384
    ds_read_b128 v[104:107], v10 offset:480
    s_waitcnt lgkmcnt(4)
    v_mfma_f32_32x32x16_bf16 v[128:143], v[108:111], v[112:115], v[128:143]
    ds_read_b128 v[108:111], v9 offset:416
    ds_read_b128 v[112:115], v10 offset:512
    s_waitcnt lgkmcnt(4)
    v_mfma_f32_32x32x16_bf16 v[128:143], v[116:119], v[120:123], v[128:143]
    ds_read_b128 v[116:119], v9 offset:448
    ds_read_b128 v[120:123], v10 offset:560
    s_waitcnt lgkmcnt(4)
    v_mfma_f32_32x32x16_bf16 v[128:143], v[100:103], v[104:107], v[128:143]
    ds_read_b128 v[100:103], v9 offset:480
    ds_read_b128 v[104:107], v10 offset:592
    s_waitcnt lgkmcnt(4)
    v_mfma_f32_32x32x16_bf16 v[128:143], v[108:111], v[112:115], v[128:143]
    ds_read_b128 v[108:111], v9 offset:512
    ds_read_b128 v[112:115], v10 offset:640
    s_waitcnt lgkmcnt(4)
    v_mfma_f32_32x32x16_bf16 v[128:143], v[116:119], v[120:123], v[128:143]
    ds_read_b128 v[116:119], v9 offset:544
    ds_read_b128 v[120:123], v10 offset:672
    s_waitcnt lgkmcnt(4)
    v_mfma_f32_32x32x16_bf16 v[128:143], v[100:103], v[104:107], v[128:143]
    ds_read_b128 v[100:103], v9 offset:576
    ds_read_b128 v[104:107], v10 offset:720
    s_waitcnt lgkmcnt(4)
    v_mfma_f32_32x32x16_bf16 v[128:143], v[108:111], v[112:115], v[128:143]
    ds_read_b128 v[108:111], v9 offset:608
    ds_read_b128 v[112:115], v10 offset:752
    s_waitcnt lgkmcnt(4)
    v_mfma_f32_32x32x16_bf16 v[128:143], v[116:119], v[120:123], v[128:143]
    ds_read_b128 v[116:119], v9 offset:640
    ds_read_b128 v[120:123], v10 offset:800
    s_waitcnt lgkmcnt(4)
    v_mfma_f32_32x32x16_bf16 v[128:143], v[100:103], v[104:107], v[128:143]
    ds_read_b128 v[100:103], v9 offset:672
    ds_read_b128 v[104:107], v10 offset:832
    s_waitcnt lgkmcnt(4)
    v_mfma_f32_32x32x16_bf16 v[128:143], v[108:111], v[112:115], v[128:143]
    ds_read_b128 v[108:111], v9 offset:704
    ds_read_b128 v[112:115], v10 offset:880
    s_waitcnt lgkmcnt(4)
    v_mfma_f32_32x32x16_bf16 v[128:143], v[116:119], v[120:123], v[128:143]
    ds_read_b128 v[116:119], v9 offset:736
    ds_read_b128 v[120:123], v10 offset:912
    s_waitcnt lgkmcnt(4)
    v_mfma_f32_32x32x16_bf16 v[128:143], v[100:103], v[104:107], v[128:143]
    ds_read_b128 v[100:103], v9 offset:768
    ds_read_b128 v[104:107], v10 offset:960
    s_waitcnt lgkmcnt(4)
    v_mfma_f32_32x32x16_bf16 v[128:143], v[108:111], v[112:115], v[128:143]
    ds_read_b128 v[108:111], v9 offset:800
    ds_read_b128 v[112:115], v10 offset:992
    s_waitcnt lgkmcnt(4)
    v_mfma_f32_32x32x16_bf16 v[128:143], v[116:119], v[120:123], v[128:143]
    ds_read_b128 v[116:119], v9 offset:832
    ds_read_b128 v[120:123], v10 offset:1040
    s_waitcnt lgkmcnt(4)
    v_mfma_f32_32x32x16_bf16 v[128:143], v[100:103], v[104:107], v[128:143]
    ds_read_b128 v[100:103], v9 offset:864
    ds_read_b128 v[104:107], v10 offset:1072
    s_waitcnt lgkmcnt(4)
    v_mfma_f32_32x32x16_bf16 v[128:143], v[108:111], v[112:115], v[128:143]
    ds_read_b128 v[108:111], v9 offset:896
    ds_read_b128 v[112:115], v10 offset:1120
    s_waitcnt lgkmcnt(4)
    v_mfma_f32_32x32x16_bf16 v[128:143], v[116:119], v[120:123], v[128:143]
    ds_read_b128 v[116:119], v9 offset:928
    ds_read_b128 v[120:123], v10 offset:1152
    s_waitcnt lgkmcnt(4)
    v_mfma_f32_32x32x16_bf16 v[128:143], v[100:103], v[104:107], v[128:143]
    ds_read_b128 v[100:103], v9 offset:960
    ds_read_b128 v[104:107], v10 offset:1200
    s_waitcnt lgkmcnt(4)
    v_mfma_f32_32x32x16_bf16 v[128:143], v[108:111], v[112:115], v[128:143]
    ds_read_b128 v[108:111], v9 offset:992
    ds_read_b128 v[112:115], v10 offset:1232
    s_waitcnt lgkmcnt(4)
    v_mfma_f32_32x32x16_bf16 v[128:143], v[116:119], v[120:123], v[128:143]
    ds_read_b128 v[116:119], v9 offset:1024
    ds_read_b128 v[120:123], v10 offset:1280
    s_waitcnt lgkmcnt(4)
    v_mfma_f32_32x32x16_bf16 v[128:143], v[100:103], v[104:107], v[128:143]
    ds_read_b128 v[100:103], v9 offset:1056
    ds_read_b128 v[104:107], v10 offset:1312
    s_waitcnt lgkmcnt(4)
    v_mfma_f32_32x32x16_bf16 v[128:143], v[108:111], v[112:115], v[128:143]
    ds_read_b128 v[108:111], v9 offset:1088
    ds_read_b128 v[112:115], v10 offset:1360
    s_waitcnt lgkmcnt(4)
    v_mfma_f32_32x32x16_bf16 v[128:143], v[116:119], v[120:123], v[128:143]
    ds_read_b128 v[116:119], v9 offset:1120
    ds_read_b128 v[120:123], v10 offset:1392
    s_waitcnt lgkmcnt(4)
    v_mfma_f32_32x32x16_bf16 v[128:143], v[100:103], v[104:107], v[128:143]
    ds_read_b128 v[100:103], v9 offset:1152
    ds_read_b128 v[104:107], v10 offset:1440
    s_waitcnt lgkmcnt(4)
    v_mfma_f32_32x32x16_bf16 v[128:143], v[108:111], v[112:115], v[128:143]
    ds_read_b128 v[108:111], v9 offset:1184
    ds_read_b128 v[112:115], v10 offset:1472
    s_waitcnt lgkmcnt(4)
    v_mfma_f32_32x32x16_bf16 v[128:143], v[116:119], v[120:123], v[128:143]
    ds_read_b128 v[116:119], v9 offset:1216
    ds_read_b128 v[120:123], v10 offset:1520
    s_waitcnt lgkmcnt(4)
    v_mfma_f32_32x32x16_bf16 v[128:143], v[100:103], v[104:107], v[128:143]
    ds_read_b128 v[100:103], v9 offset:1248
    ds_read_b128 v[104:107], v10 offset:1552
    s_waitcnt lgkmcnt(4)
    v_mfma_f32_32x32x16_bf16 v[128:143], v[108:111], v[112:115], v[128:143]
    ds_read_b128 v[108:111], v9 offset:1280
    ds_read_b128 v[112:115], v10 offset:1600
    s_waitcnt lgkmcnt(4)
    v_mfma_f32_32x32x16_bf16 v[128:143], v[116:119], v[120:123], v[128:143]
    ds_read_b128 v[116:119], v9 offset:1312
    ds_read_b128 v[120:123], v10 offset:1632
    s_waitcnt lgkmcnt(4)
    v_mfma_f32_32x32x16_bf16 v[128:143], v[100:103], v[104:107], v[128:143]
    ds_read_b128 v[100:103], v9 offset:1344
    ds_read_b128 v[104:107], v10 offset:1680
    s_waitcnt lgkmcnt(4)
    v_mfma_f32_32x32x16_bf16 v[128:143], v[108:111], v[112:115], v[128:143]
    ds_read_b128 v[108:111], v9 offset:1376
    ds_read_b128 v[112:115], v10 offset:1712
    s_waitcnt lgkmcnt(4)
    v_mfma_f32_32x32x16_bf16 v[128:143], v[116:119], v[120:123], v[128:143]
    ds_read_b128 v[116:119], v9 offset:1408
    ds_read_b128 v[120:123], v10 offset:1760
    s_waitcnt lgkmcnt(4)
    v_mfma_f32_32x32x16_bf16 v[128:143], v[100:103], v[104:107], v[128:143]
    ds_read_b128 v[100:103], v9 offset:1440
    ds_read_b128 v[104:107], v10 offset:1792
    s_waitcnt lgkmcnt(4)
    v_mfma_f32_32x32x16_bf16 v[128:143], v[108:111], v[112:115], v[128:143]
    ds_read_b128 v[108:111], v9 offset:1472
    ds_read_b128 v[112:115], v10 offset:1840
    s_waitcnt lgkmcnt(4)
    v_mfma_f32_32x32x16_bf16 v[128:143], v[116:119], v[120:123], v[128:143]
    ds_read_b128 v[116:119], v9 offset:1504
    ds_read_b128 v[120:123], v10 offset:1872
    s_waitcnt lgkmcnt(4)
    v_mfma_f32_32x32x16_bf16 v[128:143], v[100:103], v[104:107], v[128:143]
    ds_read_b128 v[100:103], v9 offset:1536
    ds_read_b128 v[104:107], v10 offset:1920
    s_waitcnt lgkmcnt(4)
    v_mfma_f32_32x32x16_bf16 v[128:143], v[108:111], v[112:115], v[128:143]
    ds_read_b128 v[108:111], v9 offset:1568
    ds_read_b128 v[112:115], v10 offset:1952
    s_waitcnt lgkmcnt(4)
    v_mfma_f32_32x32x16_bf16 v[128:143], v[116:119], v[120:123], v[128:143]
    ds_read_b128 v[116:119], v9 offset:1600
    ds_read_b128 v[120:123], v10 offset:2000
    s_waitcnt lgkmcnt(4)
    v_mfma_f32_32x32x16_bf16 v[128:143], v[100:103], v[104:107], v[128:143]
    ds_read_b128 v[100:103], v9 offset:1632
    ds_read_b128 v[104:107], v10 offset:2032
    s_waitcnt lgkmcnt(4)
    v_mfma_f32_32x32x16_bf16 v[128:143], v[108:111], v[112:115], v[128:143]
    ds_read_b128 v[108:111], v9 offset:1664
    ds_read_b128 v[112:115], v10 offset:2080
    s_waitcnt lgkmcnt(4)
    v_mfma_f32_32x32x16_bf16 v[128:143], v[116:119], v[120:123], v[128:143]
    ds_read_b128 v[116:119], v9 offset:1696
    ds_read_b128 v[120:123], v10 offset:2112
    s_waitcnt lgkmcnt(4)
    v_mfma_f32_32x32x16_bf16 v[128:143], v[100:103], v[104:107], v[128:143]
    ds_read_b128 v[100:103], v9 offset:1728
    ds_read_b128 v[104:107], v10 offset:2160
    s_waitcnt lgkmcnt(4)
    v_mfma_f32_32x32x16_bf16 v[128:143], v[108:111], v[112:115], v[128:143]
    ds_read_b128 v[108:111], v9 offset:1760
    ds_read_b128 v[112:115], v10 offset:2192
    s_waitcnt lgkmcnt(4)
    v_mfma_f32_32x32x16_bf16 v[128:143], v[116:119], v[120:123], v[128:143]
    ds_read_b128 v[116:119], v9 offset:1792
    ds_read_b128 v[120:123], v10 offset:2240
    s_waitcnt lgkmcnt(4)
    v_mfma_f32_32x32x16_bf16 v[128:143], v[100:103], v[104:107], v[128:143]
    ds_read_b128 v[100:103], v9 offset:1824
    ds_read_b128 v[104:107], v10 offset:2272
    s_waitcnt lgkmcnt(4)
    v_mfma_f32_32x32x16_bf16 v[128:143], v[108:111], v[112:115], v[128:143]
    ds_read_b128 v[108:111], v9 offset:1856
    ds_read_b128 v[112:115], v10 offset:2320
    s_waitcnt lgkmcnt(4)
    v_mfma_f32_32x32x16_bf16 v[128:143], v[116:119], v[120:123], v[128:143]
    ds_read_b128 v[116:119], v9 offset:1888
    ds_read_b128 v[120:123], v10 offset:2352
    s_waitcnt lgkmcnt(4)
    v_mfma_f32_32x32x16_bf16 v[128:143], v[100:103], v[104:107], v[128:143]
    ds_read_b128 v[100:103], v9 offset:1920
    ds_read_b128 v[104:107], v10 offset:2400
    s_waitcnt lgkmcnt(4)
    v_mfma_f32_32x32x16_bf16 v[128:143], v[108:111], v[112:115], v[128:143]
    ds_read_b128 v[108:111], v9 offset:1952
    ds_read_b128 v[112:115], v10 offset:2432
    s_waitcnt lgkmcnt(4)
    v_mfma_f32_32x32x16_bf16 v[128:143], v[116:119], v[120:123], v[128:143]
    ds_read_b128 v[116:119], v9 offset:1984
    ds_read_b128 v[120:123], v10 offset:2480
    s_waitcnt lgkmcnt(4)
    v_mfma_f32_32x32x16_bf16 v[128:143], v[100:103], v[104:107], v[128:143]
    ds_read_b128 v[100:103], v9 offset:2016
    ds_read_b128 v[104:107], v10 offset:2512
    s_waitcnt lgkmcnt(4)
    v_mfma_f32_32x32x16_bf16 v[128:143], v[108:111], v[112:115], v[128:143]
    s_waitcnt lgkmcnt(2)
    v_mfma_f32_32x32x16_bf16 v[128:143], v[116:119], v[120:123], v[128:143]
    s_waitcnt lgkmcnt(0)
    v_mfma_f32_32x32x16_bf16 v[128:143], v[100:103], v[104:107], v[128:143]
CV_RED:
    s_nop 7
    s_nop 7
    s_barrier
    v_lshlrev_b32 v9, 4, v0
    v_add_u32 v9, s85, v9
    s_cmp_eq_u32 s81, 2
    s_cbranch_scc0 CV_R2
    ds_write_b128 v9, v[128:131] offset:0
    ds_write_b128 v9, v[132:135] offset:1024
    ds_write_b128 v9, v[136:139] offset:2048
    ds_write_b128 v9, v[140:143] offset:3072
CV_R2:
    s_waitcnt lgkmcnt(0)
    s_barrier
    s_cmp_ge_u32 s81, 2
    s_cbranch_scc1 CV_END
    s_cmp_eq_u32 s81, 1
    s_cbranch_scc0 CV_R3
    ds_read_b128 v[100:103], v9 offset:0
    ds_read_b128 v[104:107], v9 offset:1024
    ds_read_b128 v[108:111], v9 offset:2048
    ds_read_b128 v[112:115], v9 offset:3072
    s_waitcnt lgkmcnt(0)
    v_add_f32 v128, v128, v100
    v_add_f32 v129, v129, v101
    v_add_f32 v130, v130, v102
    v_add_f32 v131, v131, v103
    v_add_f32 v132, v132, v104
    v_add_f32 v133, v133, v105
    v_add_f32 v134, v134, v106
    v_add_f32 v135, v135, v107
    v_add_f32 v136, v136, v108
    v_add_f32 v137, v137, v109
    v_add_f32 v138, v138, v110
    v_add_f32 v139, v139, v111
    v_add_f32 v140, v140, v112
    v_add_f32 v141, v141, v113
    v_add_f32 v142, v142, v114
    v_add_f32 v143, v143, v115
CV_R3:
    s_lshl_b32 s5, s84, 1
    v_mov_b32 v11, s5
    buffer_load_ushort v11, v11, s[28:31], 0 offen
    s_lshl_b32 s5, s86, 5
    s_add_u32 s5, s5, 32
    v_add_u32 v10, s5, v7
    v_mul_u32_u24 v10, 80, v10
    v_lshl_add_u32 v10, v8, 3, v10
    s_add_u32 s5, s85, 33920
    v_add_u32 v10, s5, v10
    ds_read_b64 v[100:101], v10 offset:0
    ds_read_b64 v[102:103], v10 offset:16
    ds_read_b64 v[104:105], v10 offset:32
    ds_read_b64 v[106:107], v10 offset:48
    s_lshl_b32 s5, s86, 5
    v_add_u32 v12, s5, v7
    v_lshlrev_b32 v12, 6, v12
    v_lshl_add_u32 v12, v8, 3, v12
    s_lshl_b32 s5, s84, 12
    s_add_u32 s5, s5, 14680064
    v_add_u32 v12, s5, v12
    s_waitcnt vmcnt(0) lgkmcnt(0)
    v_lshlrev_b32 v11, 16, v11
    v_cvt_pk_bf16_f32 v13, v128, v129
    v_lshlrev_b32 v128, 16, v13
    v_and_b32 v129, 0xffff0000, v13
    v_cvt_pk_bf16_f32 v13, v130, v131
    v_lshlrev_b32 v130, 16, v13
    v_and_b32 v131, 0xffff0000, v13
    v_lshlrev_b32 v14, 16, v100
    v_and_b32 v15, 0xffff0000, v100
    v_lshlrev_b32 v16, 16, v101
    v_and_b32 v17, 0xffff0000, v101
    v_mul_f32 v14, v14, v11
    v_mul_f32 v15, v15, v11
    v_mul_f32 v16, v16, v11
    v_mul_f32 v17, v17, v11
    v_cvt_pk_bf16_f32 v13, v14, v15
    v_lshlrev_b32 v14, 16, v13
    v_and_b32 v15, 0xffff0000, v13
    v_cvt_pk_bf16_f32 v13, v16, v17
    v_lshlrev_b32 v16, 16, v13
    v_and_b32 v17, 0xffff0000, v13
    v_add_f32 v14, v14, v128
    v_add_f32 v15, v15, v129
    v_add_f32 v16, v16, v130
    v_add_f32 v17, v17, v131
    v_cvt_pk_bf16_f32 v18, v14, v15
    v_cvt_pk_bf16_f32 v19, v16, v17
    buffer_store_dwordx2 v[18:19], v12, s[48:51], 0 offen offset:0
    v_cvt_pk_bf16_f32 v13, v132, v133
    v_lshlrev_b32 v132, 16, v13
    v_and_b32 v133, 0xffff0000, v13
    v_cvt_pk_bf16_f32 v13, v134, v135
    v_lshlrev_b32 v134, 16, v13
    v_and_b32 v135, 0xffff0000, v13
    v_lshlrev_b32 v14, 16, v102
    v_and_b32 v15, 0xffff0000, v102
    v_lshlrev_b32 v16, 16, v103
    v_and_b32 v17, 0xffff0000, v103
    v_mul_f32 v14, v14, v11
    v_mul_f32 v15, v15, v11
    v_mul_f32 v16, v16, v11
    v_mul_f32 v17, v17, v11
    v_cvt_pk_bf16_f32 v13, v14, v15
    v_lshlrev_b32 v14, 16, v13
    v_and_b32 v15, 0xffff0000, v13
    v_cvt_pk_bf16_f32 v13, v16, v17
    v_lshlrev_b32 v16, 16, v13
    v_and_b32 v17, 0xffff0000, v13
    v_add_f32 v14, v14, v132
    v_add_f32 v15, v15, v133
    v_add_f32 v16, v16, v134
    v_add_f32 v17, v17, v135
    v_cvt_pk_bf16_f32 v18, v14, v15
    v_cvt_pk_bf16_f32 v19, v16, v17
    buffer_store_dwordx2 v[18:19], v12, s[48:51], 0 offen offset:16
    v_cvt_pk_bf16_f32 v13, v136, v137
    v_lshlrev_b32 v136, 16, v13
    v_and_b32 v137, 0xffff0000, v13
    v_cvt_pk_bf16_f32 v13, v138, v139
    v_lshlrev_b32 v138, 16, v13
    v_and_b32 v139, 0xffff0000, v13
    v_lshlrev_b32 v14, 16, v104
    v_and_b32 v15, 0xffff0000, v104
    v_lshlrev_b32 v16, 16, v105
    v_and_b32 v17, 0xffff0000, v105
    v_mul_f32 v14, v14, v11
    v_mul_f32 v15, v15, v11
    v_mul_f32 v16, v16, v11
    v_mul_f32 v17, v17, v11
    v_cvt_pk_bf16_f32 v13, v14, v15
    v_lshlrev_b32 v14, 16, v13
    v_and_b32 v15, 0xffff0000, v13
    v_cvt_pk_bf16_f32 v13, v16, v17
    v_lshlrev_b32 v16, 16, v13
    v_and_b32 v17, 0xffff0000, v13
    v_add_f32 v14, v14, v136
    v_add_f32 v15, v15, v137
    v_add_f32 v16, v16, v138
    v_add_f32 v17, v17, v139
    v_cvt_pk_bf16_f32 v18, v14, v15
    v_cvt_pk_bf16_f32 v19, v16, v17
    buffer_store_dwordx2 v[18:19], v12, s[48:51], 0 offen offset:32
    v_cvt_pk_bf16_f32 v13, v140, v141
    v_lshlrev_b32 v140, 16, v13
    v_and_b32 v141, 0xffff0000, v13
    v_cvt_pk_bf16_f32 v13, v142, v143
    v_lshlrev_b32 v142, 16, v13
    v_and_b32 v143, 0xffff0000, v13
    v_lshlrev_b32 v14, 16, v106
    v_and_b32 v15, 0xffff0000, v106
    v_lshlrev_b32 v16, 16, v107
    v_and_b32 v17, 0xffff0000, v107
    v_mul_f32 v14, v14, v11
    v_mul_f32 v15, v15, v11
    v_mul_f32 v16, v16, v11
    v_mul_f32 v17, v17, v11
    v_cvt_pk_bf16_f32 v13, v14, v15
    v_lshlrev_b32 v14, 16, v13
    v_and_b32 v15, 0xffff0000, v13
    v_cvt_pk_bf16_f32 v13, v16, v17
    v_lshlrev_b32 v16, 16, v13
    v_and_b32 v17, 0xffff0000, v13
    v_add_f32 v14, v14, v140
    v_add_f32 v15, v15, v141
    v_add_f32 v16, v16, v142
    v_add_f32 v17, v17, v143
    v_cvt_pk_bf16_f32 v18, v14, v15
    v_cvt_pk_bf16_f32 v19, v16, v17
    buffer_store_dwordx2 v[18:19], v12, s[48:51], 0 offen offset:48
CV_END:
g1_kernel_END:
    s_endpgm
.globl g2_kernel
.p2align 8
.type g2_kernel,@function
g2_kernel:
    s_cmp_ge_u32 s2, 256
    s_cbranch_scc1 g2_kernel_END
    s_load_dwordx4 s[52:55], s[0:1], 0
    s_load_dwordx4 s[56:59], s[0:1], 16
    s_load_dwordx4 s[60:63], s[0:1], 32
    s_load_dwordx4 s[64:67], s[0:1], 56
    s_load_dwordx4 s[68:71], s[0:1], 72
    s_load_dwordx4 s[72:75], s[0:1], 88
    v_lshrrev_b32 v1, 6, v0
    s_nop 0
    v_readfirstlane_b32 s4, v1
    v_and_b32 v0, 63, v0
    s_waitcnt lgkmcnt(0)
    s_mov_b32 s8, s52
    s_and_b32 s9, s53, 0xffff
    s_mov_b32 s10, 2621440
    s_mov_b32 s11, 0x00020000
    s_mov_b32 s12, s54
    s_and_b32 s13, s55, 0xffff
    s_mov_b32 s14, 2621440
    s_mov_b32 s15, 0x00020000
    s_mov_b32 s16, s56
    s_and_b32 s17, s57, 0xffff
    s_mov_b32 s18, 2621440
    s_mov_b32 s19, 0x00020000
    s_mov_b32 s20, s58
    s_and_b32 s21, s59, 0xffff
    s_mov_b32 s22, 5120
    s_mov_b32 s23, 0x00020000
    s_mov_b32 s24, s60
    s_and_b32 s25, s61, 0xffff
    s_mov_b32 s26, 2621440
    s_mov_b32 s27, 0x00020000
    s_mov_b32 s28, s62
    s_and_b32 s29, s63, 0xffff
    s_mov_b32 s30, 1280
    s_mov_b32 s31, 0x00020000
    s_mov_b32 s32, s64
    s_and_b32 s33, s65, 0xffff
    s_mov_b32 s34, 2211840
    s_mov_b32 s35, 0x00020000
    s_mov_b32 s36, s66
    s_and_b32 s37, s67, 0xffff
    s_mov_b32 s38, 2211840
    s_mov_b32 s39, 0x00020000
    s_mov_b32 s40, s68
    s_and_b32 s41, s69, 0xffff
    s_mov_b32 s42, 2211840
    s_mov_b32 s43, 0x00020000
    s_mov_b32 s44, s70
    s_and_b32 s45, s71, 0xffff
    s_mov_b32 s46, 2621440
    s_mov_b32 s47, 0x00020000
    s_mov_b32 s48, s74
    s_and_b32 s49, s75, 0xffff
    s_mov_b32 s50, 33554432
    s_mov_b32 s51, 0x00020000
    s_lshr_b32 s76, s2, 3
    s_and_b32 s77, s2, 7
    s_mul_i32 s78, s4, 15360
    v_add_u32 v7, 0, v0
    s_mov_b32 s5, 6554
    v_mul_u32_u24 v8, s5, v7
    v_lshrrev_b32 v8, 16, v8
    v_mul_u32_u24 v9, 10, v8
    v_sub_u32 v9, v7, v9
    v_mul_u32_u24 v8, 1280, v8
    v_lshl_add_u32 v2, v9, 4, v8
    s_mul_i32 s5, s77, 160
    v_add_u32 v2, s5, v2
    v_add_u32 v7, 64, v0
    s_mov_b32 s5, 6554
    v_mul_u32_u24 v8, s5, v7
    v_lshrrev_b32 v8, 16, v8
    v_mul_u32_u24 v9, 10, v8
    v_sub_u32 v9, v7, v9
    v_mul_u32_u24 v8, 1280, v8
    v_lshl_add_u32 v3, v9, 4, v8
    s_mul_i32 s5, s77, 160
    v_add_u32 v3, s5, v3
    v_add_u32 v7, 128, v0
    s_mov_b32 s5, 6554
    v_mul_u32_u24 v8, s5, v7
    v_lshrrev_b32 v8, 16, v8
    v_mul_u32_u24 v9, 10, v8
    v_sub_u32 v9, v7, v9
    v_mul_u32_u24 v8, 1280, v8
    v_lshl_add_u32 v4, v9, 4, v8
    s_mul_i32 s5, s77, 160
    v_add_u32 v4, s5, v4
    v_add_u32 v7, 192, v0
    s_mov_b32 s5, 6554
    v_mul_u32_u24 v8, s5, v7
    v_lshrrev_b32 v8, 16, v8
    v_mul_u32_u24 v9, 10, v8
    v_sub_u32 v9, v7, v9
    v_mul_u32_u24 v8, 1280, v8
    v_lshl_add_u32 v5, v9, 4, v8
    s_mul_i32 s5, s77, 160
    v_add_u32 v5, s5, v5
    v_add_u32 v7, 256, v0
    s_mov_b32 s5, 6554
    v_mul_u32_u24 v8, s5, v7
    v_lshrrev_b32 v8, 16, v8
    v_mul_u32_u24 v9, 10, v8
    v_sub_u32 v9, v7, v9
    v_mul_u32_u24 v8, 1280, v8
    v_lshl_add_u32 v6, v9, 4, v8
    s_mul_i32 s5, s77, 160
    v_add_u32 v6, s5, v6
    s_mul_i32 s5, s76, 221184
    s_add_u32 s5, s5, 6291456
    v_lshlrev_b32 v7, 4, v0
    v_add_u32 v7, s5, v7
    v_and_b32 v9, 15, v0
    v_lshrrev_b32 v10, 2, v9
    v_and_b32 v9, 3, v9
    v_lshrrev_b32 v11, 4, v0
    v_lshl_add_u32 v10, v11, 3, v10
    v_mul_u32_u24 v10, 160, v10
    v_lshl_add_u32 v8, v9, 3, v10
    v_add_u32 v8, s78, v8
    v_mov_b32 v128, 0
    v_mov_b32 v129, 0
    v_mov_b32 v130, 0
    v_mov_b32 v131, 0
    v_mov_b32 v132, 0
    v_mov_b32 v133, 0
    v_mov_b32 v134, 0
    v_mov_b32 v135, 0
    v_mov_b32 v136, 0
    v_mov_b32 v137, 0
    v_mov_b32 v138, 0
    v_mov_b32 v139, 0
    v_mov_b32 v140, 0
    v_mov_b32 v141, 0
    v_mov_b32 v142, 0
    v_mov_b32 v143, 0
    v_mov_b32 v144, 0
    v_mov_b32 v145, 0
    v_mov_b32 v146, 0
    v_mov_b32 v147, 0
    v_mov_b32 v148, 0
    v_mov_b32 v149, 0
    v_mov_b32 v150, 0
    v_mov_b32 v151, 0
    v_mov_b32 v152, 0
    v_mov_b32 v153, 0
    v_mov_b32 v154, 0
    v_mov_b32 v155, 0
    v_mov_b32 v156, 0
    v_mov_b32 v157, 0
    v_mov_b32 v158, 0
    v_mov_b32 v159, 0
    v_mov_b32 v160, 0
    v_mov_b32 v161, 0
    v_mov_b32 v162, 0
    v_mov_b32 v163, 0
    v_mov_b32 v164, 0
    v_mov_b32 v165, 0
    v_mov_b32 v166, 0
    v_mov_b32 v167, 0
    v_mov_b32 v168, 0
    v_mov_b32 v169, 0
    v_mov_b32 v170, 0
    v_mov_b32 v171, 0
    v_mov_b32 v172, 0
    v_mov_b32 v173, 0
    v_mov_b32 v174, 0
    v_mov_b32 v175, 0
    v_mov_b32 v176, 0
    v_mov_b32 v177, 0
    v_mov_b32 v178, 0
    v_mov_b32 v179, 0
    v_mov_b32 v180, 0
    v_mov_b32 v181, 0
    v_mov_b32 v182, 0
    v_mov_b32 v183, 0
    v_mov_b32 v184, 0
    v_mov_b32 v185, 0
    v_mov_b32 v186, 0
    v_mov_b32 v187, 0
    v_mov_b32 v188, 0
    v_mov_b32 v189, 0
    v_mov_b32 v190, 0
    v_mov_b32 v191, 0
    v_mov_b32 v192, 0
    v_mov_b32 v193, 0
    v_mov_b32 v194, 0
    v_mov_b32 v195, 0
    v_mov_b32 v196, 0
    v_mov_b32 v197, 0
    v_mov_b32 v198, 0
    v_mov_b32 v199, 0
    v_mov_b32 v200, 0
    v_mov_b32 v201, 0
    v_mov_b32 v202, 0
    v_mov_b32 v203, 0
    v_mov_b32 v204, 0
    v_mov_b32 v205, 0
    v_mov_b32 v206, 0
    v_mov_b32 v207, 0
    v_add_u32 v21, 55296, v7
    v_add_u32 v22, 110592, v7
    v_add_u32 v23, 165888, v7
    s_add_u32 s80, s4, 0
    s_mul_i32 s81, s80, 40960
    s_lshl_b32 s82, s80, 10
    s_add_u32 m0, s78, 0
    s_nop 0
    buffer_load_dwordx4 v2, s[40:43], s81 offen lds
    s_add_u32 m0, s78, 1024
    s_nop 0
    buffer_load_dwordx4 v3, s[40:43], s81 offen lds
    s_add_u32 m0, s78, 2048
    s_nop 0
    buffer_load_dwordx4 v4, s[40:43], s81 offen lds
    s_add_u32 m0, s78, 3072
    s_nop 0
    buffer_load_dwordx4 v5, s[40:43], s81 offen lds
    s_add_u32 m0, s78, 4096
    s_nop 0
    buffer_load_dwordx4 v6, s[40:43], s81 offen lds
    buffer_load_dwordx4 v[64:67], v7, s[48:51], s82 offen offset:0
    buffer_load_dwordx4 v[68:71], v21, s[48:51], s82 offen
    buffer_load_dwordx4 v[72:75], v22, s[48:51], s82 offen
    buffer_load_dwordx4 v[76:79], v23, s[48:51], s82 offen
    s_add_u32 s80, s4, 8
    s_mul_i32 s81, s80, 40960
    s_lshl_b32 s82, s80, 10
    s_add_u32 m0, s78, 5120
    s_nop 0
    buffer_load_dwordx4 v2, s[40:43], s81 offen lds
    s_add_u32 m0, s78, 6144
    s_nop 0
    buffer_load_dwordx4 v3, s[40:43], s81 offen lds
    s_add_u32 m0, s78, 7168
    s_nop 0
    buffer_load_dwordx4 v4, s[40:43], s81 offen lds
    s_add_u32 m0, s78, 8192
    s_nop 0
    buffer_load_dwordx4 v5, s[40:43], s81 offen lds
    s_add_u32 m0, s78, 9216
    s_nop 0
    buffer_load_dwordx4 v6, s[40:43], s81 offen lds
    buffer_load_dwordx4 v[80:83], v7, s[48:51], s82 offen offset:0
    buffer_load_dwordx4 v[84:87], v21, s[48:51], s82 offen
    buffer_load_dwordx4 v[88:91], v22, s[48:51], s82 offen
    buffer_load_dwordx4 v[92:95], v23, s[48:51], s82 offen
    s_add_u32 s80, s4, 16
    s_mul_i32 s81, s80, 40960
    s_lshl_b32 s82, s80, 10
    s_add_u32 m0, s78, 10240
    s_nop 0
    buffer_load_dwordx4 v2, s[40:43], s81 offen lds
    s_add_u32 m0, s78, 11264
    s_nop 0
    buffer_load_dwordx4 v3, s[40:43], s81 offen lds
    s_add_u32 m0, s78, 12288
    s_nop 0
    buffer_load_dwordx4 v4, s[40:43], s81 offen lds
    s_add_u32 m0, s78, 13312
    s_nop 0
    buffer_load_dwordx4 v5, s[40:43], s81 offen lds
    s_add_u32 m0, s78, 14336
    s_nop 0
    buffer_load_dwordx4 v6, s[40:43], s81 offen lds
    buffer_load_dwordx4 v[96:99], v7, s[48:51], s82 offen offset:0
    buffer_load_dwordx4 v[100:103], v21, s[48:51], s82 offen
    buffer_load_dwordx4 v[104:107], v22, s[48:51], s82 offen
    buffer_load_dwordx4 v[108:111], v23, s[48:51], s82 offen
    s_waitcnt vmcnt(18)
    ds_read_b64_tr_b16 v[208:209], v8 offset:0
    ds_read_b64_tr_b16 v[210:211], v8 offset:640
    ds_read_b64_tr_b16 v[212:213], v8 offset:32
    ds_read_b64_tr_b16 v[214:215], v8 offset:672
    ds_read_b64_tr_b16 v[216:217], v8 offset:64
    ds_read_b64_tr_b16 v[218:219], v8 offset:704
    ds_read_b64_tr_b16 v[220:221], v8 offset:96
    ds_read_b64_tr_b16 v[222:223], v8 offset:736
    ds_read_b64_tr_b16 v[224:225], v8 offset:128
    ds_read_b64_tr_b16 v[226:227], v8 offset:768
    s_waitcnt lgkmcnt(0)
    v_mfma_f32_16x16x32_bf16 v[128:131], v[208:211], v[64:67], v[128:131]
    v_mfma_f32_16x16x32_bf16 v[132:135], v[208:211], v[68:71], v[132:135]
    v_mfma_f32_16x16x32_bf16 v[136:139], v[208:211], v[72:75], v[136:139]
    v_mfma_f32_16x16x32_bf16 v[140:143], v[208:211], v[76:79], v[140:143]
    v_mfma_f32_16x16x32_bf16 v[144:147], v[212:215], v[64:67], v[144:147]
    v_mfma_f32_16x16x32_bf16 v[148:151], v[212:215], v[68:71], v[148:151]
    v_mfma_f32_16x16x32_bf16 v[152:155], v[212:215], v[72:75], v[152:155]
    v_mfma_f32_16x16x32_bf16 v[156:159], v[212:215], v[76:79], v[156:159]
    v_mfma_f32_16x16x32_bf16 v[160:163], v[216:219], v[64:67], v[160:163]
    v_mfma_f32_16x16x32_bf16 v[164:167], v[216:219], v[68:71], v[164:167]
    v_mfma_f32_16x16x32_bf16 v[168:171], v[216:219], v[72:75], v[168:171]
    v_mfma_f32_16x16x32_bf16 v[172:175], v[216:219], v[76:79], v[172:175]
    v_mfma_f32_16x16x32_bf16 v[176:179], v[220:223], v[64:67], v[176:179]
    v_mfma_f32_16x16x32_bf16 v[180:183], v[220:223], v[68:71], v[180:183]
    v_mfma_f32_16x16x32_bf16 v[184:187], v[220:223], v[72:75], v[184:187]
    v_mfma_f32_16x16x32_bf16 v[188:191], v[220:223], v[76:79], v[188:191]
    v_mfma_f32_16x16x32_bf16 v[192:195], v[224:227], v[64:67], v[192:195]
    v_mfma_f32_16x16x32_bf16 v[196:199], v[224:227], v[68:71], v[196:199]
    v_mfma_f32_16x16x32_bf16 v[200:203], v[224:227], v[72:75], v[200:203]
    v_mfma_f32_16x16x32_bf16 v[204:207], v[224:227], v[76:79], v[204:207]
    s_add_u32 s80, s4, 24
    s_mul_i32 s81, s80, 40960
    s_lshl_b32 s82, s80, 10
    s_add_u32 m0, s78, 0
    s_nop 0
    buffer_load_dwordx4 v2, s[40:43], s81 offen lds
    s_add_u32 m0, s78, 1024
    s_nop 0
    buffer_load_dwordx4 v3, s[40:43], s81 offen lds
    s_add_u32 m0, s78, 2048
    s_nop 0
    buffer_load_dwordx4 v4, s[40:43], s81 offen lds
    s_add_u32 m0, s78, 3072
    s_nop 0
    buffer_load_dwordx4 v5, s[40:43], s81 offen lds
    s_add_u32 m0, s78, 4096
    s_nop 0
    buffer_load_dwordx4 v6, s[40:43], s81 offen lds
    buffer_load_dwordx4 v[64:67], v7, s[48:51], s82 offen offset:0
    buffer_load_dwordx4 v[68:71], v21, s[48:51], s82 offen
    buffer_load_dwordx4 v[72:75], v22, s[48:51], s82 offen
    buffer_load_dwordx4 v[76:79], v23, s[48:51], s82 offen
    s_waitcnt vmcnt(18)
    ds_read_b64_tr_b16 v[208:209], v8 offset:5120
    ds_read_b64_tr_b16 v[210:211], v8 offset:5760
    ds_read_b64_tr_b16 v[212:213], v8 offset:5152
    ds_read_b64_tr_b16 v[214:215], v8 offset:5792
    ds_read_b64_tr_b16 v[216:217], v8 offset:5184
    ds_read_b64_tr_b16 v[218:219], v8 offset:5824
    ds_read_b64_tr_b16 v[220:221], v8 offset:5216
    ds_read_b64_tr_b16 v[222:223], v8 offset:5856
    ds_read_b64_tr_b16 v[224:225], v8 offset:5248
    ds_read_b64_tr_b16 v[226:227], v8 offset:5888
    s_waitcnt lgkmcnt(0)
    v_mfma_f32_16x16x32_bf16 v[128:131], v[208:211], v[80:83], v[128:131]
    v_mfma_f32_16x16x32_bf16 v[132:135], v[208:211], v[84:87], v[132:135]
    v_mfma_f32_16x16x32_bf16 v[136:139], v[208:211], v[88:91], v[136:139]
    v_mfma_f32_16x16x32_bf16 v[140:143], v[208:211], v[92:95], v[140:143]
    v_mfma_f32_16x16x32_bf16 v[144:147], v[212:215], v[80:83], v[144:147]
    v_mfma_f32_16x16x32_bf16 v[148:151], v[212:215], v[84:87], v[148:151]
    v_mfma_f32_16x16x32_bf16 v[152:155], v[212:215], v[88:91], v[152:155]
    v_mfma_f32_16x16x32_bf16 v[156:159], v[212:215], v[92:95], v[156:159]
    v_mfma_f32_16x16x32_bf16 v[160:163], v[216:219], v[80:83], v[160:163]
    v_mfma_f32_16x16x32_bf16 v[164:167], v[216:219], v[84:87], v[164:167]
    v_mfma_f32_16x16x32_bf16 v[168:171], v[216:219], v[88:91], v[168:171]
    v_mfma_f32_16x16x32_bf16 v[172:175], v[216:219], v[92:95], v[172:175]
    v_mfma_f32_16x16x32_bf16 v[176:179], v[220:223], v[80:83], v[176:179]
    v_mfma_f32_16x16x32_bf16 v[180:183], v[220:223], v[84:87], v[180:183]
    v_mfma_f32_16x16x32_bf16 v[184:187], v[220:223], v[88:91], v[184:187]
    v_mfma_f32_16x16x32_bf16 v[188:191], v[220:223], v[92:95], v[188:191]
    v_mfma_f32_16x16x32_bf16 v[192:195], v[224:227], v[80:83], v[192:195]
    v_mfma_f32_16x16x32_bf16 v[196:199], v[224:227], v[84:87], v[196:199]
    v_mfma_f32_16x16x32_bf16 v[200:203], v[224:227], v[88:91], v[200:203]
    v_mfma_f32_16x16x32_bf16 v[204:207], v[224:227], v[92:95], v[204:207]
    s_add_u32 s80, s4, 32
    s_mul_i32 s81, s80, 40960
    s_lshl_b32 s82, s80, 10
    s_add_u32 m0, s78, 5120
    s_nop 0
    buffer_load_dwordx4 v2, s[40:43], s81 offen lds
    s_add_u32 m0, s78, 6144
    s_nop 0
    buffer_load_dwordx4 v3, s[40:43], s81 offen lds
    s_add_u32 m0, s78, 7168
    s_nop 0
    buffer_load_dwordx4 v4, s[40:43], s81 offen lds
    s_add_u32 m0, s78, 8192
    s_nop 0
    buffer_load_dwordx4 v5, s[40:43], s81 offen lds
    s_add_u32 m0, s78, 9216
    s_nop 0
    buffer_load_dwordx4 v6, s[40:43], s81 offen lds
    buffer_load_dwordx4 v[80:83], v7, s[48:51], s82 offen offset:0
    buffer_load_dwordx4 v[84:87], v21, s[48:51], s82 offen
    buffer_load_dwordx4 v[88:91], v22, s[48:51], s82 offen
    buffer_load_dwordx4 v[92:95], v23, s[48:51], s82 offen
    s_waitcnt vmcnt(18)
    ds_read_b64_tr_b16 v[208:209], v8 offset:10240
    ds_read_b64_tr_b16 v[210:211], v8 offset:10880
    ds_read_b64_tr_b16 v[212:213], v8 offset:10272
    ds_read_b64_tr_b16 v[214:215], v8 offset:10912
    ds_read_b64_tr_b16 v[216:217], v8 offset:10304
    ds_read_b64_tr_b16 v[218:219], v8 offset:10944
    ds_read_b64_tr_b16 v[220:221], v8 offset:10336
    ds_read_b64_tr_b16 v[222:223], v8 offset:10976
    ds_read_b64_tr_b16 v[224:225], v8 offset:10368
    ds_read_b64_tr_b16 v[226:227], v8 offset:11008
    s_waitcnt lgkmcnt(0)
    v_mfma_f32_16x16x32_bf16 v[128:131], v[208:211], v[96:99], v[128:131]
    v_mfma_f32_16x16x32_bf16 v[132:135], v[208:211], v[100:103], v[132:135]
    v_mfma_f32_16x16x32_bf16 v[136:139], v[208:211], v[104:107], v[136:139]
    v_mfma_f32_16x16x32_bf16 v[140:143], v[208:211], v[108:111], v[140:143]
    v_mfma_f32_16x16x32_bf16 v[144:147], v[212:215], v[96:99], v[144:147]
    v_mfma_f32_16x16x32_bf16 v[148:151], v[212:215], v[100:103], v[148:151]
    v_mfma_f32_16x16x32_bf16 v[152:155], v[212:215], v[104:107], v[152:155]
    v_mfma_f32_16x16x32_bf16 v[156:159], v[212:215], v[108:111], v[156:159]
    v_mfma_f32_16x16x32_bf16 v[160:163], v[216:219], v[96:99], v[160:163]
    v_mfma_f32_16x16x32_bf16 v[164:167], v[216:219], v[100:103], v[164:167]
    v_mfma_f32_16x16x32_bf16 v[168:171], v[216:219], v[104:107], v[168:171]
    v_mfma_f32_16x16x32_bf16 v[172:175], v[216:219], v[108:111], v[172:175]
    v_mfma_f32_16x16x32_bf16 v[176:179], v[220:223], v[96:99], v[176:179]
    v_mfma_f32_16x16x32_bf16 v[180:183], v[220:223], v[100:103], v[180:183]
    v_mfma_f32_16x16x32_bf16 v[184:187], v[220:223], v[104:107], v[184:187]
    v_mfma_f32_16x16x32_bf16 v[188:191], v[220:223], v[108:111], v[188:191]
    v_mfma_f32_16x16x32_bf16 v[192:195], v[224:227], v[96:99], v[192:195]
    v_mfma_f32_16x16x32_bf16 v[196:199], v[224:227], v[100:103], v[196:199]
    v_mfma_f32_16x16x32_bf16 v[200:203], v[224:227], v[104:107], v[200:203]
    v_mfma_f32_16x16x32_bf16 v[204:207], v[224:227], v[108:111], v[204:207]
    s_add_u32 s80, s4, 40
    s_mul_i32 s81, s80, 40960
    s_lshl_b32 s82, s80, 10
    s_add_u32 m0, s78, 10240
    s_nop 0
    buffer_load_dwordx4 v2, s[40:43], s81 offen lds
    s_add_u32 m0, s78, 11264
    s_nop 0
    buffer_load_dwordx4 v3, s[40:43], s81 offen lds
    s_add_u32 m0, s78, 12288
    s_nop 0
    buffer_load_dwordx4 v4, s[40:43], s81 offen lds
    s_add_u32 m0, s78, 13312
    s_nop 0
    buffer_load_dwordx4 v5, s[40:43], s81 offen lds
    s_add_u32 m0, s78, 14336
    s_nop 0
    buffer_load_dwordx4 v6, s[40:43], s81 offen lds
    buffer_load_dwordx4 v[96:99], v7, s[48:51], s82 offen offset:0
    buffer_load_dwordx4 v[100:103], v21, s[48:51], s82 offen
    buffer_load_dwordx4 v[104:107], v22, s[48:51], s82 offen
    buffer_load_dwordx4 v[108:111], v23, s[48:51], s82 offen
    s_waitcnt vmcnt(18)
    ds_read_b64_tr_b16 v[208:209], v8 offset:0
    ds_read_b64_tr_b16 v[210:211], v8 offset:640
    ds_read_b64_tr_b16 v[212:213], v8 offset:32
    ds_read_b64_tr_b16 v[214:215], v8 offset:672
    ds_read_b64_tr_b16 v[216:217], v8 offset:64
    ds_read_b64_tr_b16 v[218:219], v8 offset:704
    ds_read_b64_tr_b16 v[220:221], v8 offset:96
    ds_read_b64_tr_b16 v[222:223], v8 offset:736
    ds_read_b64_tr_b16 v[224:225], v8 offset:128
    ds_read_b64_tr_b16 v[226:227], v8 offset:768
    s_waitcnt lgkmcnt(0)
    v_mfma_f32_16x16x32_bf16 v[128:131], v[208:211], v[64:67], v[128:131]
    v_mfma_f32_16x16x32_bf16 v[132:135], v[208:211], v[68:71], v[132:135]
    v_mfma_f32_16x16x32_bf16 v[136:139], v[208:211], v[72:75], v[136:139]
    v_mfma_f32_16x16x32_bf16 v[140:143], v[208:211], v[76:79], v[140:143]
    v_mfma_f32_16x16x32_bf16 v[144:147], v[212:215], v[64:67], v[144:147]
    v_mfma_f32_16x16x32_bf16 v[148:151], v[212:215], v[68:71], v[148:151]
    v_mfma_f32_16x16x32_bf16 v[152:155], v[212:215], v[72:75], v[152:155]
    v_mfma_f32_16x16x32_bf16 v[156:159], v[212:215], v[76:79], v[156:159]
    v_mfma_f32_16x16x32_bf16 v[160:163], v[216:219], v[64:67], v[160:163]
    v_mfma_f32_16x16x32_bf16 v[164:167], v[216:219], v[68:71], v[164:167]
    v_mfma_f32_16x16x32_bf16 v[168:171], v[216:219], v[72:75], v[168:171]
    v_mfma_f32_16x16x32_bf16 v[172:175], v[216:219], v[76:79], v[172:175]
    v_mfma_f32_16x16x32_bf16 v[176:179], v[220:223], v[64:67], v[176:179]
    v_mfma_f32_16x16x32_bf16 v[180:183], v[220:223], v[68:71], v[180:183]
    v_mfma_f32_16x16x32_bf16 v[184:187], v[220:223], v[72:75], v[184:187]
    v_mfma_f32_16x16x32_bf16 v[188:191], v[220:223], v[76:79], v[188:191]
    v_mfma_f32_16x16x32_bf16 v[192:195], v[224:227], v[64:67], v[192:195]
    v_mfma_f32_16x16x32_bf16 v[196:199], v[224:227], v[68:71], v[196:199]
    v_mfma_f32_16x16x32_bf16 v[200:203], v[224:227], v[72:75], v[200:203]
    v_mfma_f32_16x16x32_bf16 v[204:207], v[224:227], v[76:79], v[204:207]
    s_cmp_ge_u32 s4, 6
    s_cbranch_scc1 G2_L5
    s_add_u32 s80, s4, 48
    s_mul_i32 s81, s80, 40960
    s_lshl_b32 s82, s80, 10
    s_add_u32 m0, s78, 0
    s_nop 0
    buffer_load_dwordx4 v2, s[40:43], s81 offen lds
    s_add_u32 m0, s78, 1024
    s_nop 0
    buffer_load_dwordx4 v3, s[40:43], s81 offen lds
    s_add_u32 m0, s78, 2048
    s_nop 0
    buffer_load_dwordx4 v4, s[40:43], s81 offen lds
    s_add_u32 m0, s78, 3072
    s_nop 0
    buffer_load_dwordx4 v5, s[40:43], s81 offen lds
    s_add_u32 m0, s78, 4096
    s_nop 0
    buffer_load_dwordx4 v6, s[40:43], s81 offen lds
    buffer_load_dwordx4 v[64:67], v7, s[48:51], s82 offen offset:0
    buffer_load_dwordx4 v[68:71], v21, s[48:51], s82 offen
    buffer_load_dwordx4 v[72:75], v22, s[48:51], s82 offen
    buffer_load_dwordx4 v[76:79], v23, s[48:51], s82 offen
    s_waitcnt vmcnt(18)
    s_branch G2_L5b
G2_L5:
    s_waitcnt vmcnt(9)
G2_L5b:
    ds_read_b64_tr_b16 v[208:209], v8 offset:5120
    ds_read_b64_tr_b16 v[210:211], v8 offset:5760
    ds_read_b64_tr_b16 v[212:213], v8 offset:5152
    ds_read_b64_tr_b16 v[214:215], v8 offset:5792
    ds_read_b64_tr_b16 v[216:217], v8 offset:5184
    ds_read_b64_tr_b16 v[218:219], v8 offset:5824
    ds_read_b64_tr_b16 v[220:221], v8 offset:5216
    ds_read_b64_tr_b16 v[222:223], v8 offset:5856
    ds_read_b64_tr_b16 v[224:225], v8 offset:5248
    ds_read_b64_tr_b16 v[226:227], v8 offset:5888
    s_waitcnt lgkmcnt(0)
    v_mfma_f32_16x16x32_bf16 v[128:131], v[208:211], v[80:83], v[128:131]
    v_mfma_f32_16x16x32_bf16 v[132:135], v[208:211], v[84:87], v[132:135]
    v_mfma_f32_16x16x32_bf16 v[136:139], v[208:211], v[88:91], v[136:139]
    v_mfma_f32_16x16x32_bf16 v[140:143], v[208:211], v[92:95], v[140:143]
    v_mfma_f32_16x16x32_bf16 v[144:147], v[212:215], v[80:83], v[144:147]
    v_mfma_f32_16x16x32_bf16 v[148:151], v[212:215], v[84:87], v[148:151]
    v_mfma_f32_16x16x32_bf16 v[152:155], v[212:215], v[88:91], v[152:155]
    v_mfma_f32_16x16x32_bf16 v[156:159], v[212:215], v[92:95], v[156:159]
    v_mfma_f32_16x16x32_bf16 v[160:163], v[216:219], v[80:83], v[160:163]
    v_mfma_f32_16x16x32_bf16 v[164:167], v[216:219], v[84:87], v[164:167]
    v_mfma_f32_16x16x32_bf16 v[168:171], v[216:219], v[88:91], v[168:171]
    v_mfma_f32_16x16x32_bf16 v[172:175], v[216:219], v[92:95], v[172:175]
    v_mfma_f32_16x16x32_bf16 v[176:179], v[220:223], v[80:83], v[176:179]
    v_mfma_f32_16x16x32_bf16 v[180:183], v[220:223], v[84:87], v[180:183]
    v_mfma_f32_16x16x32_bf16 v[184:187], v[220:223], v[88:91], v[184:187]
    v_mfma_f32_16x16x32_bf16 v[188:191], v[220:223], v[92:95], v[188:191]
    v_mfma_f32_16x16x32_bf16 v[192:195], v[224:227], v[80:83], v[192:195]
    v_mfma_f32_16x16x32_bf16 v[196:199], v[224:227], v[84:87], v[196:199]
    v_mfma_f32_16x16x32_bf16 v[200:203], v[224:227], v[88:91], v[200:203]
    v_mfma_f32_16x16x32_bf16 v[204:207], v[224:227], v[92:95], v[204:207]
    s_cmp_ge_u32 s4, 6
    s_cbranch_scc1 G2_L6
    s_waitcnt vmcnt(9)
    s_branch G2_L6b
G2_L6:
    s_waitcnt vmcnt(0)
G2_L6b:
    ds_read_b64_tr_b16 v[208:209], v8 offset:10240
    ds_read_b64_tr_b16 v[210:211], v8 offset:10880
    ds_read_b64_tr_b16 v[212:213], v8 offset:10272
    ds_read_b64_tr_b16 v[214:215], v8 offset:10912
    ds_read_b64_tr_b16 v[216:217], v8 offset:10304
    ds_read_b64_tr_b16 v[218:219], v8 offset:10944
    ds_read_b64_tr_b16 v[220:221], v8 offset:10336
    ds_read_b64_tr_b16 v[222:223], v8 offset:10976
    ds_read_b64_tr_b16 v[224:225], v8 offset:10368
    ds_read_b64_tr_b16 v[226:227], v8 offset:11008
    s_waitcnt lgkmcnt(0)
    v_mfma_f32_16x16x32_bf16 v[128:131], v[208:211], v[96:99], v[128:131]
    v_mfma_f32_16x16x32_bf16 v[132:135], v[208:211], v[100:103], v[132:135]
    v_mfma_f32_16x16x32_bf16 v[136:139], v[208:211], v[104:107], v[136:139]
    v_mfma_f32_16x16x32_bf16 v[140:143], v[208:211], v[108:111], v[140:143]
    v_mfma_f32_16x16x32_bf16 v[144:147], v[212:215], v[96:99], v[144:147]
    v_mfma_f32_16x16x32_bf16 v[148:151], v[212:215], v[100:103], v[148:151]
    v_mfma_f32_16x16x32_bf16 v[152:155], v[212:215], v[104:107], v[152:155]
    v_mfma_f32_16x16x32_bf16 v[156:159], v[212:215], v[108:111], v[156:159]
    v_mfma_f32_16x16x32_bf16 v[160:163], v[216:219], v[96:99], v[160:163]
    v_mfma_f32_16x16x32_bf16 v[164:167], v[216:219], v[100:103], v[164:167]
    v_mfma_f32_16x16x32_bf16 v[168:171], v[216:219], v[104:107], v[168:171]
    v_mfma_f32_16x16x32_bf16 v[172:175], v[216:219], v[108:111], v[172:175]
    v_mfma_f32_16x16x32_bf16 v[176:179], v[220:223], v[96:99], v[176:179]
    v_mfma_f32_16x16x32_bf16 v[180:183], v[220:223], v[100:103], v[180:183]
    v_mfma_f32_16x16x32_bf16 v[184:187], v[220:223], v[104:107], v[184:187]
    v_mfma_f32_16x16x32_bf16 v[188:191], v[220:223], v[108:111], v[188:191]
    v_mfma_f32_16x16x32_bf16 v[192:195], v[224:227], v[96:99], v[192:195]
    v_mfma_f32_16x16x32_bf16 v[196:199], v[224:227], v[100:103], v[196:199]
    v_mfma_f32_16x16x32_bf16 v[200:203], v[224:227], v[104:107], v[200:203]
    v_mfma_f32_16x16x32_bf16 v[204:207], v[224:227], v[108:111], v[204:207]
    s_cmp_ge_u32 s4, 6
    s_cbranch_scc1 G2_DONE
    s_waitcnt vmcnt(0)
    ds_read_b64_tr_b16 v[208:209], v8 offset:0
    ds_read_b64_tr_b16 v[210:211], v8 offset:640
    ds_read_b64_tr_b16 v[212:213], v8 offset:32
    ds_read_b64_tr_b16 v[214:215], v8 offset:672
    ds_read_b64_tr_b16 v[216:217], v8 offset:64
    ds_read_b64_tr_b16 v[218:219], v8 offset:704
    ds_read_b64_tr_b16 v[220:221], v8 offset:96
    ds_read_b64_tr_b16 v[222:223], v8 offset:736
    ds_read_b64_tr_b16 v[224:225], v8 offset:128
    ds_read_b64_tr_b16 v[226:227], v8 offset:768
    s_waitcnt lgkmcnt(0)
    v_mfma_f32_16x16x32_bf16 v[128:131], v[208:211], v[64:67], v[128:131]
    v_mfma_f32_16x16x32_bf16 v[132:135], v[208:211], v[68:71], v[132:135]
    v_mfma_f32_16x16x32_bf16 v[136:139], v[208:211], v[72:75], v[136:139]
    v_mfma_f32_16x16x32_bf16 v[140:143], v[208:211], v[76:79], v[140:143]
    v_mfma_f32_16x16x32_bf16 v[144:147], v[212:215], v[64:67], v[144:147]
    v_mfma_f32_16x16x32_bf16 v[148:151], v[212:215], v[68:71], v[148:151]
    v_mfma_f32_16x16x32_bf16 v[152:155], v[212:215], v[72:75], v[152:155]
    v_mfma_f32_16x16x32_bf16 v[156:159], v[212:215], v[76:79], v[156:159]
    v_mfma_f32_16x16x32_bf16 v[160:163], v[216:219], v[64:67], v[160:163]
    v_mfma_f32_16x16x32_bf16 v[164:167], v[216:219], v[68:71], v[164:167]
    v_mfma_f32_16x16x32_bf16 v[168:171], v[216:219], v[72:75], v[168:171]
    v_mfma_f32_16x16x32_bf16 v[172:175], v[216:219], v[76:79], v[172:175]
    v_mfma_f32_16x16x32_bf16 v[176:179], v[220:223], v[64:67], v[176:179]
    v_mfma_f32_16x16x32_bf16 v[180:183], v[220:223], v[68:71], v[180:183]
    v_mfma_f32_16x16x32_bf16 v[184:187], v[220:223], v[72:75], v[184:187]
    v_mfma_f32_16x16x32_bf16 v[188:191], v[220:223], v[76:79], v[188:191]
    v_mfma_f32_16x16x32_bf16 v[192:195], v[224:227], v[64:67], v[192:195]
    v_mfma_f32_16x16x32_bf16 v[196:199], v[224:227], v[68:71], v[196:199]
    v_mfma_f32_16x16x32_bf16 v[200:203], v[224:227], v[72:75], v[200:203]
    v_mfma_f32_16x16x32_bf16 v[204:207], v[224:227], v[76:79], v[204:207]
G2_DONE:
    s_nop 7
    s_nop 7
    s_lshl_b32 s6, s4, 6
    v_add_u32 v1, s6, v0
    s_barrier
    s_mul_i32 s5, s4, 10240
    v_lshlrev_b32 v9, 4, v0
    v_add_u32 v9, s5, v9
    ds_write_b128 v9, v[128:131] offset:0
    ds_write_b128 v9, v[132:135] offset:1024
    ds_write_b128 v9, v[136:139] offset:2048
    ds_write_b128 v9, v[140:143] offset:3072
    ds_write_b128 v9, v[144:147] offset:4096
    ds_write_b128 v9, v[148:151] offset:5120
    ds_write_b128 v9, v[152:155] offset:6144
    ds_write_b128 v9, v[156:159] offset:7168
    ds_write_b128 v9, v[160:163] offset:8192
    ds_write_b128 v9, v[164:167] offset:9216
    s_waitcnt lgkmcnt(0)
    s_barrier
    v_lshlrev_b32 v9, 4, v1
    ds_read_b128 v[96:99], v9 offset:0
    ds_read_b128 v[100:103], v9 offset:10240
    ds_read_b128 v[104:107], v9 offset:20480
    ds_read_b128 v[108:111], v9 offset:30720
    ds_read_b128 v[112:115], v9 offset:40960
    ds_read_b128 v[116:119], v9 offset:51200
    ds_read_b128 v[120:123], v9 offset:61440
    v_add_u32 v10, 61440, v9
    ds_read_b128 v[124:127], v10 offset:10240
    s_waitcnt lgkmcnt(0)
    v_add_f32 v96, v96, v100
    v_add_f32 v104, v104, v108
    v_add_f32 v112, v112, v116
    v_add_f32 v120, v120, v124
    v_add_f32 v96, v96, v104
    v_add_f32 v112, v112, v120
    v_add_f32 v208, v96, v112
    v_add_f32 v97, v97, v101
    v_add_f32 v105, v105, v109
    v_add_f32 v113, v113, v117
    v_add_f32 v121, v121, v125
    v_add_f32 v97, v97, v105
    v_add_f32 v113, v113, v121
    v_add_f32 v209, v97, v113
    v_add_f32 v98, v98, v102
    v_add_f32 v106, v106, v110
    v_add_f32 v114, v114, v118
    v_add_f32 v122, v122, v126
    v_add_f32 v98, v98, v106
    v_add_f32 v114, v114, v122
    v_add_f32 v210, v98, v114
    v_add_f32 v99, v99, v103
    v_add_f32 v107, v107, v111
    v_add_f32 v115, v115, v119
    v_add_f32 v123, v123, v127
    v_add_f32 v99, v99, v107
    v_add_f32 v115, v115, v123
    v_add_f32 v211, v99, v115
    v_cmp_gt_u32 vcc, 128, v1
    s_and_saveexec_b64 s[6:7], vcc
    s_cbranch_execz G2_S1
    v_lshlrev_b32 v9, 4, v1
    v_add_u32 v9, 8192, v9
    ds_read_b128 v[96:99], v9 offset:0
    ds_read_b128 v[100:103], v9 offset:10240
    ds_read_b128 v[104:107], v9 offset:20480
    ds_read_b128 v[108:111], v9 offset:30720
    ds_read_b128 v[112:115], v9 offset:40960
    ds_read_b128 v[116:119], v9 offset:51200
    ds_read_b128 v[120:123], v9 offset:61440
    v_add_u32 v10, 61440, v9
    ds_read_b128 v[124:127], v10 offset:10240
    s_waitcnt lgkmcnt(0)
    v_add_f32 v96, v96, v100
    v_add_f32 v104, v104, v108
    v_add_f32 v112, v112, v116
    v_add_f32 v120, v120, v124
    v_add_f32 v96, v96, v104
    v_add_f32 v112, v112, v120
    v_add_f32 v212, v96, v112
    v_add_f32 v97, v97, v101
    v_add_f32 v105, v105, v109
    v_add_f32 v113, v113, v117
    v_add_f32 v121, v121, v125
    v_add_f32 v97, v97, v105
    v_add_f32 v113, v113, v121
    v_add_f32 v213, v97, v113
    v_add_f32 v98, v98, v102
    v_add_f32 v106, v106, v110
    v_add_f32 v114, v114, v118
    v_add_f32 v122, v122, v126
    v_add_f32 v98, v98, v106
    v_add_f32 v114, v114, v122
    v_add_f32 v214, v98, v114
    v_add_f32 v99, v99, v103
    v_add_f32 v107, v107, v111
    v_add_f32 v115, v115, v119
    v_add_f32 v123, v123, v127
    v_add_f32 v99, v99, v107
    v_add_f32 v115, v115, v123
    v_add_f32 v215, v99, v115
G2_S1:
    s_mov_b64 exec, s[6:7]
    s_barrier
    s_mul_i32 s5, s4, 10240
    v_lshlrev_b32 v9, 4, v0
    v_add_u32 v9, s5, v9
    ds_write_b128 v9, v[168:171] offset:0
    ds_write_b128 v9, v[172:175] offset:1024
    ds_write_b128 v9, v[176:179] offset:2048
    ds_write_b128 v9, v[180:183] offset:3072
    ds_write_b128 v9, v[184:187] offset:4096
    ds_write_b128 v9, v[188:191] offset:5120
    ds_write_b128 v9, v[192:195] offset:6144
    ds_write_b128 v9, v[196:199] offset:7168
    ds_write_b128 v9, v[200:203] offset:8192
    ds_write_b128 v9, v[204:207] offset:9216
    s_waitcnt lgkmcnt(0)
    s_barrier
    v_lshlrev_b32 v9, 4, v1
    ds_read_b128 v[96:99], v9 offset:0
    ds_read_b128 v[100:103], v9 offset:10240
    ds_read_b128 v[104:107], v9 offset:20480
    ds_read_b128 v[108:111], v9 offset:30720
    ds_read_b128 v[112:115], v9 offset:40960
    ds_read_b128 v[116:119], v9 offset:51200
    ds_read_b128 v[120:123], v9 offset:61440
    v_add_u32 v10, 61440, v9
    ds_read_b128 v[124:127], v10 offset:10240
    s_waitcnt lgkmcnt(0)
    v_add_f32 v96, v96, v100
    v_add_f32 v104, v104, v108
    v_add_f32 v112, v112, v116
    v_add_f32 v120, v120, v124
    v_add_f32 v96, v96, v104
    v_add_f32 v112, v112, v120
    v_add_f32 v216, v96, v112
    v_add_f32 v97, v97, v101
    v_add_f32 v105, v105, v109
    v_add_f32 v113, v113, v117
    v_add_f32 v121, v121, v125
    v_add_f32 v97, v97, v105
    v_add_f32 v113, v113, v121
    v_add_f32 v217, v97, v113
    v_add_f32 v98, v98, v102
    v_add_f32 v106, v106, v110
    v_add_f32 v114, v114, v118
    v_add_f32 v122, v122, v126
    v_add_f32 v98, v98, v106
    v_add_f32 v114, v114, v122
    v_add_f32 v218, v98, v114
    v_add_f32 v99, v99, v103
    v_add_f32 v107, v107, v111
    v_add_f32 v115, v115, v119
    v_add_f32 v123, v123, v127
    v_add_f32 v99, v99, v107
    v_add_f32 v115, v115, v123
    v_add_f32 v219, v99, v115
    v_cmp_gt_u32 vcc, 128, v1
    s_and_saveexec_b64 s[6:7], vcc
    s_cbranch_execz G2_S3
    v_lshlrev_b32 v9, 4, v1
    v_add_u32 v9, 8192, v9
    ds_read_b128 v[96:99], v9 offset:0
    ds_read_b128 v[100:103], v9 offset:10240
    ds_read_b128 v[104:107], v9 offset:20480
    ds_read_b128 v[108:111], v9 offset:30720
    ds_read_b128 v[112:115], v9 offset:40960
    ds_read_b128 v[116:119], v9 offset:51200
    ds_read_b128 v[120:123], v9 offset:61440
    v_add_u32 v10, 61440, v9
    ds_read_b128 v[124:127], v10 offset:10240
    s_waitcnt lgkmcnt(0)
    v_add_f32 v96, v96, v100
    v_add_f32 v104, v104, v108
    v_add_f32 v112, v112, v116
    v_add_f32 v120, v120, v124
    v_add_f32 v96, v96, v104
    v_add_f32 v112, v112, v120
    v_add_f32 v220, v96, v112
    v_add_f32 v97, v97, v101
    v_add_f32 v105, v105, v109
    v_add_f32 v113, v113, v117
    v_add_f32 v121, v121, v125
    v_add_f32 v97, v97, v105
    v_add_f32 v113, v113, v121
    v_add_f32 v221, v97, v113
    v_add_f32 v98, v98, v102
    v_add_f32 v106, v106, v110
    v_add_f32 v114, v114, v118
    v_add_f32 v122, v122, v126
    v_add_f32 v98, v98, v106
    v_add_f32 v114, v114, v122
    v_add_f32 v222, v98, v114
    v_add_f32 v99, v99, v103
    v_add_f32 v107, v107, v111
    v_add_f32 v115, v115, v119
    v_add_f32 v123, v123, v127
    v_add_f32 v99, v99, v107
    v_add_f32 v115, v115, v123
    v_add_f32 v223, v99, v115
G2_S3:
    s_mov_b64 exec, s[6:7]
    v_add_u32 v9, 0, v1
    v_lshrrev_b32 v10, 6, v9
    v_add_u32 v10, 0, v10
    v_and_b32 v9, 63, v9
    v_lshrrev_b32 v11, 2, v10
    v_and_b32 v12, 3, v10
    v_and_b32 v13, 15, v9
    v_lshl_add_u32 v13, v12, 4, v13
    s_lshl_b32 s5, s76, 6
    v_add_u32 v13, s5, v13
    v_lshrrev_b32 v14, 4, v9
    v_lshlrev_b32 v14, 2, v14
    v_lshl_add_u32 v14, v11, 4, v14
    s_mul_i32 s5, s77, 80
    v_add_u32 v14, s5, v14
    v_mul_u32_u24 v15, 1280, v13
    v_lshl_add_u32 v15, v14, 1, v15
    buffer_load_dwordx2 v[16:17], v15, s[8:11], 0 offen
    v_add_u32 v24, 0, v15
    buffer_load_dwordx2 v[18:19], v24, s[48:51], 0 offen
    v_lshlrev_b32 v24, 12, v14
    v_lshl_add_u32 v24, v13, 1, v24
    v_add_u32 v24, 14680064, v24
    buffer_load_ushort v20, v24, s[48:51], 0 offen offset:0
    v_add_u32 v25, 4096, v24
    buffer_load_ushort v21, v25, s[48:51], 0 offen
    v_add_u32 v25, 8192, v24
    buffer_load_ushort v22, v25, s[48:51], 0 offen
    v_add_u32 v25, 12288, v24
    buffer_load_ushort v23, v25, s[48:51], 0 offen
    s_waitcnt vmcnt(0)
    v_cvt_pk_bf16_f32 v26, v208, v209
    v_lshlrev_b32 v208, 16, v26
    v_and_b32 v209, 0xffff0000, v26
    v_cvt_pk_bf16_f32 v26, v210, v211
    v_lshlrev_b32 v210, 16, v26
    v_and_b32 v211, 0xffff0000, v26
    v_lshlrev_b32 v26, 16, v18
    v_and_b32 v27, 0xffff0000, v18
    v_lshlrev_b32 v28, 16, v19
    v_and_b32 v29, 0xffff0000, v19
    v_lshlrev_b32 v20, 16, v20
    v_mul_f32 v26, v26, v20
    v_lshlrev_b32 v21, 16, v21
    v_mul_f32 v27, v27, v21
    v_lshlrev_b32 v22, 16, v22
    v_mul_f32 v28, v28, v22
    v_lshlrev_b32 v23, 16, v23
    v_mul_f32 v29, v29, v23
    v_cvt_pk_bf16_f32 v30, v26, v27
    v_lshlrev_b32 v26, 16, v30
    v_and_b32 v27, 0xffff0000, v30
    v_cvt_pk_bf16_f32 v30, v28, v29
    v_lshlrev_b32 v28, 16, v30
    v_and_b32 v29, 0xffff0000, v30
    v_lshlrev_b32 v20, 16, v16
    v_and_b32 v21, 0xffff0000, v16
    v_lshlrev_b32 v22, 16, v17
    v_and_b32 v23, 0xffff0000, v17
    v_add_f32 v26, v26, v20
    v_add_f32 v27, v27, v21
    v_add_f32 v28, v28, v22
    v_add_f32 v29, v29, v23
    v_cvt_pk_bf16_f32 v30, v26, v27
    v_lshlrev_b32 v26, 16, v30
    v_and_b32 v27, 0xffff0000, v30
    v_cvt_pk_bf16_f32 v30, v28, v29
    v_lshlrev_b32 v28, 16, v30
    v_and_b32 v29, 0xffff0000, v30
    v_add_f32 v26, v26, v208
    v_add_f32 v27, v27, v209
    v_add_f32 v28, v28, v210
    v_add_f32 v29, v29, v211
    v_cvt_pk_bf16_f32 v16, v26, v27
    v_cvt_pk_bf16_f32 v17, v28, v29
    buffer_store_dwordx2 v[16:17], v15, s[44:47], 0 offen
    v_cmp_gt_u32 vcc, 128, v1
    s_and_saveexec_b64 s[6:7], vcc
    s_cbranch_execz G2_E1
    v_add_u32 v9, 512, v1
    v_lshrrev_b32 v10, 6, v9
    v_add_u32 v10, 0, v10
    v_and_b32 v9, 63, v9
    v_lshrrev_b32 v11, 2, v10
    v_and_b32 v12, 3, v10
    v_and_b32 v13, 15, v9
    v_lshl_add_u32 v13, v12, 4, v13
    s_lshl_b32 s5, s76, 6
    v_add_u32 v13, s5, v13
    v_lshrrev_b32 v14, 4, v9
    v_lshlrev_b32 v14, 2, v14
    v_lshl_add_u32 v14, v11, 4, v14
    s_mul_i32 s5, s77, 80
    v_add_u32 v14, s5, v14
    v_mul_u32_u24 v15, 1280, v13
    v_lshl_add_u32 v15, v14, 1, v15
    buffer_load_dwordx2 v[16:17], v15, s[8:11], 0 offen
    v_add_u32 v24, 0, v15
    buffer_load_dwordx2 v[18:19], v24, s[48:51], 0 offen
    v_lshlrev_b32 v24, 12, v14
    v_lshl_add_u32 v24, v13, 1, v24
    v_add_u32 v24, 14680064, v24
    buffer_load_ushort v20, v24, s[48:51], 0 offen offset:0
    v_add_u32 v25, 4096, v24
    buffer_load_ushort v21, v25, s[48:51], 0 offen
    v_add_u32 v25, 8192, v24
    buffer_load_ushort v22, v25, s[48:51], 0 offen
    v_add_u32 v25, 12288, v24
    buffer_load_ushort v23, v25, s[48:51], 0 offen
    s_waitcnt vmcnt(0)
    v_cvt_pk_bf16_f32 v26, v212, v213
    v_lshlrev_b32 v212, 16, v26
    v_and_b32 v213, 0xffff0000, v26
    v_cvt_pk_bf16_f32 v26, v214, v215
    v_lshlrev_b32 v214, 16, v26
    v_and_b32 v215, 0xffff0000, v26
    v_lshlrev_b32 v26, 16, v18
    v_and_b32 v27, 0xffff0000, v18
    v_lshlrev_b32 v28, 16, v19
    v_and_b32 v29, 0xffff0000, v19
    v_lshlrev_b32 v20, 16, v20
    v_mul_f32 v26, v26, v20
    v_lshlrev_b32 v21, 16, v21
    v_mul_f32 v27, v27, v21
    v_lshlrev_b32 v22, 16, v22
    v_mul_f32 v28, v28, v22
    v_lshlrev_b32 v23, 16, v23
    v_mul_f32 v29, v29, v23
    v_cvt_pk_bf16_f32 v30, v26, v27
    v_lshlrev_b32 v26, 16, v30
    v_and_b32 v27, 0xffff0000, v30
    v_cvt_pk_bf16_f32 v30, v28, v29
    v_lshlrev_b32 v28, 16, v30
    v_and_b32 v29, 0xffff0000, v30
    v_lshlrev_b32 v20, 16, v16
    v_and_b32 v21, 0xffff0000, v16
    v_lshlrev_b32 v22, 16, v17
    v_and_b32 v23, 0xffff0000, v17
    v_add_f32 v26, v26, v20
    v_add_f32 v27, v27, v21
    v_add_f32 v28, v28, v22
    v_add_f32 v29, v29, v23
    v_cvt_pk_bf16_f32 v30, v26, v27
    v_lshlrev_b32 v26, 16, v30
    v_and_b32 v27, 0xffff0000, v30
    v_cvt_pk_bf16_f32 v30, v28, v29
    v_lshlrev_b32 v28, 16, v30
    v_and_b32 v29, 0xffff0000, v30
    v_add_f32 v26, v26, v212
    v_add_f32 v27, v27, v213
    v_add_f32 v28, v28, v214
    v_add_f32 v29, v29, v215
    v_cvt_pk_bf16_f32 v16, v26, v27
    v_cvt_pk_bf16_f32 v17, v28, v29
    buffer_store_dwordx2 v[16:17], v15, s[44:47], 0 offen
G2_E1:
    s_mov_b64 exec, s[6:7]
    v_add_u32 v9, 0, v1
    v_lshrrev_b32 v10, 6, v9
    v_add_u32 v10, 10, v10
    v_and_b32 v9, 63, v9
    v_lshrrev_b32 v11, 2, v10
    v_and_b32 v12, 3, v10
    v_and_b32 v13, 15, v9
    v_lshl_add_u32 v13, v12, 4, v13
    s_lshl_b32 s5, s76, 6
    v_add_u32 v13, s5, v13
    v_lshrrev_b32 v14, 4, v9
    v_lshlrev_b32 v14, 2, v14
    v_lshl_add_u32 v14, v11, 4, v14
    s_mul_i32 s5, s77, 80
    v_add_u32 v14, s5, v14
    v_mul_u32_u24 v15, 1280, v13
    v_lshl_add_u32 v15, v14, 1, v15
    buffer_load_dwordx2 v[16:17], v15, s[8:11], 0 offen
    v_add_u32 v24, 0, v15
    buffer_load_dwordx2 v[18:19], v24, s[48:51], 0 offen
    v_lshlrev_b32 v24, 12, v14
    v_lshl_add_u32 v24, v13, 1, v24
    v_add_u32 v24, 14680064, v24
    buffer_load_ushort v20, v24, s[48:51], 0 offen offset:0
    v_add_u32 v25, 4096, v24
    buffer_load_ushort v21, v25, s[48:51], 0 offen
    v_add_u32 v25, 8192, v24
    buffer_load_ushort v22, v25, s[48:51], 0 offen
    v_add_u32 v25, 12288, v24
    buffer_load_ushort v23, v25, s[48:51], 0 offen
    s_waitcnt vmcnt(0)
    v_cvt_pk_bf16_f32 v26, v216, v217
    v_lshlrev_b32 v216, 16, v26
    v_and_b32 v217, 0xffff0000, v26
    v_cvt_pk_bf16_f32 v26, v218, v219
    v_lshlrev_b32 v218, 16, v26
    v_and_b32 v219, 0xffff0000, v26
    v_lshlrev_b32 v26, 16, v18
    v_and_b32 v27, 0xffff0000, v18
    v_lshlrev_b32 v28, 16, v19
    v_and_b32 v29, 0xffff0000, v19
    v_lshlrev_b32 v20, 16, v20
    v_mul_f32 v26, v26, v20
    v_lshlrev_b32 v21, 16, v21
    v_mul_f32 v27, v27, v21
    v_lshlrev_b32 v22, 16, v22
    v_mul_f32 v28, v28, v22
    v_lshlrev_b32 v23, 16, v23
    v_mul_f32 v29, v29, v23
    v_cvt_pk_bf16_f32 v30, v26, v27
    v_lshlrev_b32 v26, 16, v30
    v_and_b32 v27, 0xffff0000, v30
    v_cvt_pk_bf16_f32 v30, v28, v29
    v_lshlrev_b32 v28, 16, v30
    v_and_b32 v29, 0xffff0000, v30
    v_lshlrev_b32 v20, 16, v16
    v_and_b32 v21, 0xffff0000, v16
    v_lshlrev_b32 v22, 16, v17
    v_and_b32 v23, 0xffff0000, v17
    v_add_f32 v26, v26, v20
    v_add_f32 v27, v27, v21
    v_add_f32 v28, v28, v22
    v_add_f32 v29, v29, v23
    v_cvt_pk_bf16_f32 v30, v26, v27
    v_lshlrev_b32 v26, 16, v30
    v_and_b32 v27, 0xffff0000, v30
    v_cvt_pk_bf16_f32 v30, v28, v29
    v_lshlrev_b32 v28, 16, v30
    v_and_b32 v29, 0xffff0000, v30
    v_add_f32 v26, v26, v216
    v_add_f32 v27, v27, v217
    v_add_f32 v28, v28, v218
    v_add_f32 v29, v29, v219
    v_cvt_pk_bf16_f32 v16, v26, v27
    v_cvt_pk_bf16_f32 v17, v28, v29
    buffer_store_dwordx2 v[16:17], v15, s[44:47], 0 offen
    v_cmp_gt_u32 vcc, 128, v1
    s_and_saveexec_b64 s[6:7], vcc
    s_cbranch_execz G2_E3
    v_add_u32 v9, 512, v1
    v_lshrrev_b32 v10, 6, v9
    v_add_u32 v10, 10, v10
    v_and_b32 v9, 63, v9
    v_lshrrev_b32 v11, 2, v10
    v_and_b32 v12, 3, v10
    v_and_b32 v13, 15, v9
    v_lshl_add_u32 v13, v12, 4, v13
    s_lshl_b32 s5, s76, 6
    v_add_u32 v13, s5, v13
    v_lshrrev_b32 v14, 4, v9
    v_lshlrev_b32 v14, 2, v14
    v_lshl_add_u32 v14, v11, 4, v14
    s_mul_i32 s5, s77, 80
    v_add_u32 v14, s5, v14
    v_mul_u32_u24 v15, 1280, v13
    v_lshl_add_u32 v15, v14, 1, v15
    buffer_load_dwordx2 v[16:17], v15, s[8:11], 0 offen
    v_add_u32 v24, 0, v15
    buffer_load_dwordx2 v[18:19], v24, s[48:51], 0 offen
    v_lshlrev_b32 v24, 12, v14
    v_lshl_add_u32 v24, v13, 1, v24
    v_add_u32 v24, 14680064, v24
    buffer_load_ushort v20, v24, s[48:51], 0 offen offset:0
    v_add_u32 v25, 4096, v24
    buffer_load_ushort v21, v25, s[48:51], 0 offen
    v_add_u32 v25, 8192, v24
    buffer_load_ushort v22, v25, s[48:51], 0 offen
    v_add_u32 v25, 12288, v24
    buffer_load_ushort v23, v25, s[48:51], 0 offen
    s_waitcnt vmcnt(0)
    v_cvt_pk_bf16_f32 v26, v220, v221
    v_lshlrev_b32 v220, 16, v26
    v_and_b32 v221, 0xffff0000, v26
    v_cvt_pk_bf16_f32 v26, v222, v223
    v_lshlrev_b32 v222, 16, v26
    v_and_b32 v223, 0xffff0000, v26
    v_lshlrev_b32 v26, 16, v18
    v_and_b32 v27, 0xffff0000, v18
    v_lshlrev_b32 v28, 16, v19
    v_and_b32 v29, 0xffff0000, v19
    v_lshlrev_b32 v20, 16, v20
    v_mul_f32 v26, v26, v20
    v_lshlrev_b32 v21, 16, v21
    v_mul_f32 v27, v27, v21
    v_lshlrev_b32 v22, 16, v22
    v_mul_f32 v28, v28, v22
    v_lshlrev_b32 v23, 16, v23
    v_mul_f32 v29, v29, v23
    v_cvt_pk_bf16_f32 v30, v26, v27
    v_lshlrev_b32 v26, 16, v30
    v_and_b32 v27, 0xffff0000, v30
    v_cvt_pk_bf16_f32 v30, v28, v29
    v_lshlrev_b32 v28, 16, v30
    v_and_b32 v29, 0xffff0000, v30
    v_lshlrev_b32 v20, 16, v16
    v_and_b32 v21, 0xffff0000, v16
    v_lshlrev_b32 v22, 16, v17
    v_and_b32 v23, 0xffff0000, v17
    v_add_f32 v26, v26, v20
    v_add_f32 v27, v27, v21
    v_add_f32 v28, v28, v22
    v_add_f32 v29, v29, v23
    v_cvt_pk_bf16_f32 v30, v26, v27
    v_lshlrev_b32 v26, 16, v30
    v_and_b32 v27, 0xffff0000, v30
    v_cvt_pk_bf16_f32 v30, v28, v29
    v_lshlrev_b32 v28, 16, v30
    v_and_b32 v29, 0xffff0000, v30
    v_add_f32 v26, v26, v220
    v_add_f32 v27, v27, v221
    v_add_f32 v28, v28, v222
    v_add_f32 v29, v29, v223
    v_cvt_pk_bf16_f32 v16, v26, v27
    v_cvt_pk_bf16_f32 v17, v28, v29
    buffer_store_dwordx2 v[16:17], v15, s[44:47], 0 offen
G2_E3:
    s_mov_b64 exec, s[6:7]
g2_kernel_END:
    s_endpgm
.section .rodata,"a"
.p2align 6
.amdhsa_kernel p0_kernel
  .amdhsa_next_free_vgpr 256
  .amdhsa_next_free_sgpr 102
  .amdhsa_accum_offset 256
  .amdhsa_group_segment_fixed_size 0
  .amdhsa_kernarg_size 104
  .amdhsa_user_sgpr_count 2
  .amdhsa_user_sgpr_kernarg_segment_ptr 1
  .amdhsa_system_sgpr_workgroup_id_x 1
.end_amdhsa_kernel
.p2align 6
.amdhsa_kernel g1_kernel
  .amdhsa_next_free_vgpr 256
  .amdhsa_next_free_sgpr 102
  .amdhsa_accum_offset 256
  .amdhsa_group_segment_fixed_size 0
  .amdhsa_kernarg_size 104
  .amdhsa_user_sgpr_count 2
  .amdhsa_user_sgpr_kernarg_segment_ptr 1
  .amdhsa_system_sgpr_workgroup_id_x 1
.end_amdhsa_kernel
.p2align 6
.amdhsa_kernel g2_kernel
  .amdhsa_next_free_vgpr 256
  .amdhsa_next_free_sgpr 102
  .amdhsa_accum_offset 256
  .amdhsa_group_segment_fixed_size 0
  .amdhsa_kernarg_size 104
  .amdhsa_user_sgpr_count 2
  .amdhsa_user_sgpr_kernarg_segment_ptr 1
  .amdhsa_system_sgpr_workgroup_id_x 1
.end_amdhsa_kernel
```
